```python
import torch

def _softmax(x, axis=-1):
    return torch.softmax(x, dim=axis)
def _gelu(x):
    return torch.nn.functional.gelu(x, approximate="tanh")
def _silu(x):
    return torch.nn.functional.silu(x)
def _sigmoid(x):
    return torch.sigmoid(x)
def _layernorm(x, axis=-1, eps=1e-5):
    m = x.mean(dim=axis, keepdim=True)
    v = x.var(dim=axis, keepdim=True, unbiased=False)
    return (x - m) / torch.sqrt(v + eps)
def _scatter_add(tgt, idx, src, axis=0):
    return tgt.clone().index_add_(axis, idx, src)
def _segment_sum(src, seg, n):
    out = torch.zeros((n,) + src.shape[1:], dtype=src.dtype)
    return out.index_add_(0, seg, src)
def _pad(x, pw):
    flat = tuple(v for pair in reversed(pw) for v in pair)
    return torch.nn.functional.pad(x, flat)

kernel_name = 'sequential_preLN__grouped_kv_mqa__moe_arch_mod__prompt'

def setup_inputs():

    _w = (lambda a: (lambda t: t.to(torch.bfloat16) if t.is_floating_point() else t)(torch.as_tensor(a)))
    def _A_setup():
        B, S, D, H = 1, 2048, 512, 32
        Dh = D // H
        return {
            "x": _w((lambda *s: torch.randn(*s, dtype=torch.bfloat16) * 0.05)(B, S, D)),
            "wq": _w((lambda *s: torch.randn(*s, dtype=torch.bfloat16) * 0.2)(D, H * Dh)),
            "wk": _w((lambda *s: torch.randn(*s, dtype=torch.bfloat16) * 0.2)(D, Dh)),
            "wv": _w((lambda *s: torch.randn(*s, dtype=torch.bfloat16) * 0.2)(D, Dh)),
            "wo": _w((lambda *s: torch.randn(*s, dtype=torch.bfloat16) * 0.2)(H * Dh, D)),
        }
    _A_in = _A_setup()

    def _B_setup():
        B, S, D, F, C = 1, 2048, 512, 1792, 2
        return {
            "x": _w((lambda *s: torch.randn(*s, dtype=torch.bfloat16) * 0.05)(B, S, D)),
            "w_r": _w((lambda *s: torch.randn(*s, dtype=torch.bfloat16) * 0.2)(D)),
            "w_gate": _w((lambda *s: torch.randn(*s, dtype=torch.bfloat16) * 0.2)(D, F)),
            "w_up": _w((lambda *s: torch.randn(*s, dtype=torch.bfloat16) * 0.2)(D, F)),
            "w_down": _w((lambda *s: torch.randn(*s, dtype=torch.bfloat16) * 0.2)(F, D)),
        }
    _B_in = _B_setup()

    return {
        "A_x": _A_in["x"],
        "A_wq": _A_in["wq"],
        "A_wk": _A_in["wk"],
        "A_wv": _A_in["wv"],
        "A_wo": _A_in["wo"],
        "B_x": _B_in["x"],
        "B_w_r": _B_in["w_r"],
        "B_w_gate": _B_in["w_gate"],
        "B_w_up": _B_in["w_up"],
        "B_w_down": _B_in["w_down"],
    }

def reference(A_x, A_wq, A_wk, A_wv, A_wo, B_x, B_w_r, B_w_gate, B_w_up, B_w_down):
    def _A_ref(x, wq, wk, wv, wo):
        B, S, D = x.shape
        H = 32
        Dh = D // H
        q = (lambda x, *d: x.permute(*d))((x @ wq).reshape(B, S, H, Dh), 0, 2, 1, 3)
        k = x @ wk
        v = x @ wv
        scores = torch.einsum("bhqd,bkd->bhqk", q, k) * (Dh ** -0.5)
        p = _softmax(scores, axis=-1)
        o = torch.einsum("bhqk,bkd->bhqd", p, v)
        return (lambda x, *d: x.permute(*d))(o, 0, 2, 1, 3).reshape(B, S, H * Dh) @ wo

    def _B_ref(x, w_r, w_gate, w_up, w_down):
        B, S, D = x.shape
        C = 2
        r = x @ w_r
        idx = torch.argsort(-r, axis=-1)[:, :C]
        idx_e = (lambda x, n, axis: torch.repeat_interleave(x, n, dim=axis))(idx.reshape(B, C, 1), D, axis=2)
        x_sel = (lambda x, i, axis: torch.take_along_dim(x, i, dim=axis))(x, idx_e, axis=1)
        g = _silu(x_sel @ w_gate)
        u = x_sel @ w_up
        y = (g * u) @ w_down
        r_sel = _sigmoid((lambda x, i, axis: torch.take_along_dim(x, i, dim=axis))(r, idx, axis=1))
        y = y * r_sel.reshape(B, C, 1)
        b_off = (torch.arange(B) * S).reshape(B, 1)
        flat_idx = (idx + b_off).reshape(B * C)
        zero = (x * 0.0).reshape(B * S, D)
        upd = _scatter_add(zero, flat_idx, y.reshape(B * C, D), axis=0)
        return x + upd.reshape(B, S, D)

    x = A_x
    h = x + _A_ref(_layernorm(x, axis=-1), A_wq, A_wk, A_wv, A_wo)
    h2 = h + _B_ref(_layernorm(h, axis=-1), B_w_r, B_w_gate, B_w_up, B_w_down)
    return h2
```

```asm
; @launch grid=(256,1,1) block=(512,1,1) lds=149568
.amdgcn_target "amdgcn-amd-amdhsa--gfx950"
.text
.globl sequential_preLN__grouped_kv_mqa__moe_arch_mod__prompt_kernel
.p2align 8
.type sequential_preLN__grouped_kv_mqa__moe_arch_mod__prompt_kernel,@function
sequential_preLN__grouped_kv_mqa__moe_arch_mod__prompt_kernel:
    s_cmp_lt_u32 s2, 256
    s_cbranch_scc1 K1_go
    s_endpgm
K1_go:
    s_load_dwordx8 s[24:31], s[0:1], 0
    s_load_dwordx2 s[44:45], s[0:1], 32
    s_load_dwordx2 s[32:33], s[0:1], 96
    s_cmp_ge_u32 s2, 16
    s_cbranch_scc1 K1_nocp
    v_subrev_u32 v30, 256, v0
    v_cmp_gt_u32 vcc, (K_all_end-sequential_preLN__grouped_kv_mqa__moe_arch_mod__prompt_kernel+127)/128, v30
    s_and_saveexec_b64 s[62:63], vcc
    s_cbranch_execz K1_cpx
    s_getpc_b64 s[60:61]
K1_pc:
    s_sub_u32 s60, s60, K1_pc-sequential_preLN__grouped_kv_mqa__moe_arch_mod__prompt_kernel
    s_subb_u32 s61, s61, 0
    v_lshlrev_b32_e64 v30, 7, v30
    global_load_dword v31, v30, s[60:61]
K1_cpx:
    s_mov_b64 exec, s[62:63]
K1_nocp:
    s_and_b32 s3, s2, 7
    s_lshr_b32 s4, s2, 3
    s_and_b32 s5, s4, 7
    s_lshr_b32 s4, s4, 3
    s_lshl_b32 s3, s3, 2
    s_add_u32 s3, s3, s4
    v_lshrrev_b32 v160, 6, v0
    v_and_b32 v161, 63, v0
    v_readfirstlane_b32 s6, v160
    v_and_b32 v162, 15, v161
    v_lshrrev_b32 v165, 2, v161
    v_lshrrev_b32_e64 v163, 4, v161
    v_bfe_u32 v18, v161, 2, 2
    v_and_b32_e64 v19, 3, v161
    v_lshl_add_u32 v20, v163, 3, v18
    v_lshlrev_b32_e64 v17, 5, v20
    v_lshl_add_u32 v17, v19, 3, v17
    s_cmp_ge_u32 s6, 4
    s_cbranch_scc1 K1_loader
    s_load_dwordx2 s[48:49], s[0:1], 96
    s_load_dwordx2 s[40:41], s[0:1], 0
    s_load_dwordx8 s[60:67], s[0:1], 48
    s_load_dwordx2 s[46:47], s[0:1], 80
    s_lshl_b32 s7, s3, 6
    s_lshl_b32 s34, s6, 4
    s_add_u32 s7, s7, s34
    v_add_u32 v164, s7, v162
    v_lshrrev_b32 v166, 4, v161
    v_and_b32 v166, 2, v166
    v_xor_b32 v166, v166, v19
    v_lshlrev_b32 v165, 10, v165
    v_lshl_add_u32 v165, v166, 4, v165
    s_lshl_b32 s81, s6, 14
    s_lshl_b32 s80, s7, 10
    s_lshl_b32 s79, s5, 7
    s_waitcnt lgkmcnt(0)
    s_mov_b32 s16, s24
    s_mov_b32 s17, s25
    s_mov_b32 s18, 0x200000
    s_mov_b32 s19, 0x00020000
    s_add_u32 s42, s48, 0x227000
    s_addc_u32 s43, s49, 0
    s_load_dword s58, s[42:43], 0
    s_mov_b32 s29, 0
K1_x1:
    s_mov_b32 m0, s81
    s_add_u32 s3, s79, s80
    buffer_load_dwordx4 v165, s[16:19], s3 offen lds
    s_add_u32 m0, s81, 960
    s_add_u32 s79, s79, 128
    buffer_load_dwordx4 v165, s[16:19], s3 offen offset:64 lds
    s_and_b32 s79, s79, 0x3ff
    s_add_u32 s81, s81, 2048
    s_add_u32 s29, s29, 1
    s_cmp_lt_u32 s29, 2
    s_cbranch_scc1 K1_x1
    s_branch K12_setup1
K1_loader:
    s_setprio 3
    s_sub_u32 s6, s6, 4
    v_lshrrev_b32 v166, 3, v161
    v_and_b32 v167, 7, v161
    v_and_b32 v168, 2, v166
    v_xor_b32 v167, v167, v168
    v_xor_b32 v168, 4, v167
    s_lshl_b32 s35, s5, 7
    v_lshlrev_b32 v166, 10, v166
    v_add_u32 v166, s35, v166
    v_lshl_add_u32 v169, v167, 4, v166
    v_lshl_add_u32 v170, v168, 4, v166
    v_lshlrev_b32 v171, 4, v161
    v_lshlrev_b32 v41, 14, v161
    v_lshrrev_b32 v172, 1, v161
    v_lshlrev_b32 v172, 10, v172
    v_and_b32_e64 v173, 1, v161
    v_lshl_add_u32 v172, v173, 4, v172
    s_lshl_b32 s65, s6, 14
    s_add_u32 s65, s65, 65536
    s_lshl_b32 s37, s6, 4
    s_lshl_b32 s38, s5, 3
    s_add_u32 s37, s37, s38
    v_and_b32 v174, 16, v161
    v_lshlrev_b32 v174, 3, v174
    v_xor_b32_e64 v174, v174, v171
    s_lshl_b32 s39, s4, 2
    s_waitcnt lgkmcnt(0)
    s_add_u32 s56, s32, 0x227000
    s_addc_u32 s57, s33, 0
    s_load_dword s58, s[56:57], 0
    s_mov_b32 s12, s26
    s_mov_b32 s13, s27
    s_mov_b32 s14, 0x80000
    s_mov_b32 s15, 0x00020000
    s_bitcmp0_b32 s5, 0
    s_cselect_b64 s[46:47], s[28:29], s[30:31]
    s_mov_b32 s16, s46
    s_mov_b32 s17, s47
    s_mov_b32 s18, 0x4000
    s_mov_b32 s19, 0x00020000
    s_mov_b32 s40, s44
    s_mov_b32 s41, s45
    s_mov_b32 s42, 0x80000
    s_mov_b32 s43, 0x00020000
    s_mov_b32 s20, s32
    s_mov_b32 s21, s33
    s_mov_b32 s22, 0x800000
    s_mov_b32 s23, 0x00020000
    s_cmp_lg_u32 s6, 0
    s_cbranch_scc1 K1_noz
    v_mov_b32 v32, 0
    v_mov_b32 v33, 0
    v_mov_b32 v34, 0
    v_mov_b32 v35, 0
    s_lshl_b32 s48, s2, 10
    s_add_u32 s48, s48, 0x2a0000
    buffer_store_dwordx4 v[32:35], v171, s[20:23], s48 offen sc1
K1_noz:
    s_cmp_lg_u32 s6, 1
    s_cbranch_scc1 K1_not
    s_lshl_b32 s48, s3, 1
    s_lshr_b32 s49, s5, 2
    s_add_u32 s48, s48, s49
    s_mul_i32 s48, s48, 2176
    s_add_u32 s48, s48, 0x260000
    s_bfe_u32 s49, s5, 0x10001
    s_lshl_b32 s50, s49, 8
    s_mul_i32 s51, s49, 544
    s_addk_i32 s51, 1024
    s_bitcmp0_b32 s5, 0
    s_cselect_b32 s50, s50, s51
    s_add_u32 s48, s48, s50
    s_movk_i32 s51, 272
    s_bitcmp0_b32 s5, 0
    s_cselect_b32 s51, 512, s51
    s_mov_b32 s52, 0x1ffff
    s_cselect_b32 s52, 0xffff, s52
    v_lshrrev_b32_e64 v36, 5, v161
    v_mul_lo_u32 v36, v36, s51
    v_and_b32_e64 v37, 31, v161
    v_lshl_add_u32 v36, v37, 4, v36
    v_cmp_eq_u32 vcc, 16, v37
    v_mov_b32 v37, 0x3f803f80
    s_nop 0
    v_cndmask_b32 v32, -1, v37, vcc
    v_mov_b32 v33, v32
    v_mov_b32 v34, v32
    v_mov_b32 v35, v32
    s_mov_b32 exec_lo, s52
    s_mov_b32 exec_hi, s52
    buffer_store_dwordx4 v[32:35], v36, s[20:23], s48 offen sc1
    s_mov_b64 exec, -1
K1_not:
    s_cmp_lt_u32 s6, 3
    s_cbranch_scc1 K1_nowo
    s_lshl_b32 s46, s2, 1
    s_lshr_b32 s47, s46, 6
    s_lshl_b32 s47, s47, 16
    s_bfe_u32 s48, s46, 0x10002
    s_lshl_b32 s48, s48, 15
    s_add_u32 s47, s47, s48
    s_bfe_u32 s48, s46, 0x30003
    s_lshl_b32 s48, s48, 7
    s_add_u32 s47, s47, s48
    s_and_b32 s48, s46, 3
    s_lshl_b32 s48, s48, 5
    s_add_u32 s47, s47, s48
    s_mov_b32 m0, 147456
    v_add_u32 v17, 147456, v17
    buffer_load_dwordx4 v172, s[40:43], s47 offen lds
    s_mov_b32 m0, 148448
    s_nop 0
    buffer_load_dwordx4 v172, s[40:43], s47 offen offset:32 lds
K1_nowo:
    s_lshl_b32 s36, s6, 12
    s_lshl_b32 s38, s5, 11
    s_add_u32 s48, s36, 0
    s_add_u32 m0, s48, 131072
    s_add_u32 s48, s48, s38
    s_and_b32 s48, s48, 0x3fff
    buffer_load_dwordx4 v174, s[16:19], s48 offen lds
    s_add_u32 s48, s36, 1024
    s_add_u32 m0, s48, 131072
    s_add_u32 s48, s48, s38
    s_and_b32 s48, s48, 0x3fff
    buffer_load_dwordx4 v174, s[16:19], s48 offen lds
    s_add_u32 s48, s36, 2048
    s_add_u32 m0, s48, 131072
    s_add_u32 s48, s48, s38
    s_and_b32 s48, s48, 0x3fff
    buffer_load_dwordx4 v174, s[16:19], s48 offen lds
    s_add_u32 s48, s36, 3072
    s_add_u32 m0, s48, 131072
    s_add_u32 s48, s48, s38
    s_and_b32 s48, s48, 0x3fff
    buffer_load_dwordx4 v174, s[16:19], s48 offen lds
    s_waitcnt lgkmcnt(0)
    s_add_u32 s58, s58, 1
    s_barrier
    s_cmp_lt_u32 s6, 3
    s_cbranch_scc1 K1_wst
    s_waitcnt vmcnt(0)
    ds_read_b64_tr_b16 v[32:33], v17
    ds_read_b64_tr_b16 v[34:35], v17 offset:128
    ds_read_b64_tr_b16 v[36:37], v17 offset:1024
    ds_read_b64_tr_b16 v[38:39], v17 offset:1152
    s_lshl_b32 s46, s46, 10
    s_add_u32 s46, s46, 0x780000
    v_mov_b32 v40, s58
    s_lshl_b32 s35, s2, 4
    s_add_u32 s35, s35, 0x200000
    s_waitcnt lgkmcnt(0)
    buffer_store_dwordx4 v[32:35], v171, s[20:23], s46 offen sc1
    buffer_store_dwordx4 v[36:39], v171, s[20:23], s46 offen offset:1024 sc1
K1_wst:
    s_add_u32 s48, s39, 0
    s_and_b32 s48, s48, 15
    s_lshl_b32 s49, s48, 10
    s_add_u32 m0, s65, s49
    s_add_u32 s48, s48, s37
    s_and_b32 s48, s48, 63
    s_lshl_b32 s48, s48, 13
    buffer_load_dwordx4 v169, s[12:15], s48 offen lds
    s_add_u32 s48, s39, 1
    s_and_b32 s48, s48, 15
    s_lshl_b32 s49, s48, 10
    s_add_u32 m0, s65, s49
    s_add_u32 s48, s48, s37
    s_and_b32 s48, s48, 63
    s_lshl_b32 s48, s48, 13
    buffer_load_dwordx4 v170, s[12:15], s48 offen lds
    s_add_u32 s48, s39, 2
    s_and_b32 s48, s48, 15
    s_lshl_b32 s49, s48, 10
    s_add_u32 m0, s65, s49
    s_add_u32 s48, s48, s37
    s_and_b32 s48, s48, 63
    s_lshl_b32 s48, s48, 13
    buffer_load_dwordx4 v169, s[12:15], s48 offen lds
    s_add_u32 s48, s39, 3
    s_and_b32 s48, s48, 15
    s_lshl_b32 s49, s48, 10
    s_add_u32 m0, s65, s49
    s_add_u32 s48, s48, s37
    s_and_b32 s48, s48, 63
    s_lshl_b32 s48, s48, 13
    buffer_load_dwordx4 v170, s[12:15], s48 offen lds
    s_add_u32 s48, s39, 4
    s_and_b32 s48, s48, 15
    s_lshl_b32 s49, s48, 10
    s_add_u32 m0, s65, s49
    s_add_u32 s48, s48, s37
    s_and_b32 s48, s48, 63
    s_lshl_b32 s48, s48, 13
    buffer_load_dwordx4 v169, s[12:15], s48 offen lds
    s_add_u32 s48, s39, 5
    s_and_b32 s48, s48, 15
    s_lshl_b32 s49, s48, 10
    s_add_u32 m0, s65, s49
    s_add_u32 s48, s48, s37
    s_and_b32 s48, s48, 63
    s_lshl_b32 s48, s48, 13
    buffer_load_dwordx4 v170, s[12:15], s48 offen lds
    s_cmp_eq_u32 s6, 3
    s_cbranch_scc1 K1_wb
    s_waitcnt vmcnt(6)
K1_wb:
    s_barrier
    s_add_u32 s48, s39, 6
    s_and_b32 s48, s48, 15
    s_lshl_b32 s49, s48, 10
    s_add_u32 m0, s65, s49
    s_add_u32 s48, s48, s37
    s_and_b32 s48, s48, 63
    s_lshl_b32 s48, s48, 13
    buffer_load_dwordx4 v169, s[12:15], s48 offen lds
    s_add_u32 s48, s39, 7
    s_and_b32 s48, s48, 15
    s_lshl_b32 s49, s48, 10
    s_add_u32 m0, s65, s49
    s_add_u32 s48, s48, s37
    s_and_b32 s48, s48, 63
    s_lshl_b32 s48, s48, 13
    buffer_load_dwordx4 v170, s[12:15], s48 offen lds
    s_add_u32 s48, s39, 8
    s_and_b32 s48, s48, 15
    s_lshl_b32 s49, s48, 10
    s_add_u32 m0, s65, s49
    s_add_u32 s48, s48, s37
    s_and_b32 s48, s48, 63
    s_lshl_b32 s48, s48, 13
    buffer_load_dwordx4 v169, s[12:15], s48 offen lds
    s_add_u32 s48, s39, 9
    s_and_b32 s48, s48, 15
    s_lshl_b32 s49, s48, 10
    s_add_u32 m0, s65, s49
    s_add_u32 s48, s48, s37
    s_and_b32 s48, s48, 63
    s_lshl_b32 s48, s48, 13
    buffer_load_dwordx4 v170, s[12:15], s48 offen lds
    s_cmp_lt_u32 s6, 3
    s_cbranch_scc1 K1_nodn
    s_waitcnt vmcnt(10)
    s_mov_b64 exec, 0xff
    buffer_store_dword v40, v41, s[20:23], s35 offen sc1
    s_mov_b64 exec, -1
K1_nodn:
    s_add_u32 s48, s39, 10
    s_and_b32 s48, s48, 15
    s_lshl_b32 s49, s48, 10
    s_add_u32 m0, s65, s49
    s_add_u32 s48, s48, s37
    s_and_b32 s48, s48, 63
    s_lshl_b32 s48, s48, 13
    buffer_load_dwordx4 v169, s[12:15], s48 offen lds
    s_add_u32 s48, s39, 11
    s_and_b32 s48, s48, 15
    s_lshl_b32 s49, s48, 10
    s_add_u32 m0, s65, s49
    s_add_u32 s48, s48, s37
    s_and_b32 s48, s48, 63
    s_lshl_b32 s48, s48, 13
    buffer_load_dwordx4 v170, s[12:15], s48 offen lds
    s_add_u32 s48, s39, 12
    s_and_b32 s48, s48, 15
    s_lshl_b32 s49, s48, 10
    s_add_u32 m0, s65, s49
    s_add_u32 s48, s48, s37
    s_and_b32 s48, s48, 63
    s_lshl_b32 s48, s48, 13
    buffer_load_dwordx4 v169, s[12:15], s48 offen lds
    s_add_u32 s48, s39, 13
    s_and_b32 s48, s48, 15
    s_lshl_b32 s49, s48, 10
    s_add_u32 m0, s65, s49
    s_add_u32 s48, s48, s37
    s_and_b32 s48, s48, 63
    s_lshl_b32 s48, s48, 13
    buffer_load_dwordx4 v170, s[12:15], s48 offen lds
    s_add_u32 s48, s39, 14
    s_and_b32 s48, s48, 15
    s_lshl_b32 s49, s48, 10
    s_add_u32 m0, s65, s49
    s_add_u32 s48, s48, s37
    s_and_b32 s48, s48, 63
    s_lshl_b32 s48, s48, 13
    buffer_load_dwordx4 v169, s[12:15], s48 offen lds
    s_add_u32 s48, s39, 15
    s_and_b32 s48, s48, 15
    s_lshl_b32 s49, s48, 10
    s_add_u32 m0, s65, s49
    s_add_u32 s48, s48, s37
    s_and_b32 s48, s48, 63
    s_lshl_b32 s48, s48, 13
    buffer_load_dwordx4 v170, s[12:15], s48 offen lds
    s_branch K12_setup
K1_comp:
    v_lshlrev_b32_e64 v21, 7, v20
    v_lshl_add_u32 v21, v19, 3, v21
    v_add_u32 v21, 65536, v21
    v_lshrrev_b32 v22, 1, v18
    v_and_b32 v23, 1, v163
    v_lshl_or_b32 v22, v23, 1, v22
    v_xor_b32_e64 v23, 0, v22
    v_lshl_add_u32 v172, v23, 5, v21
    v_xor_b32_e64 v23, 1, v22
    v_lshl_add_u32 v173, v23, 5, v21
    v_xor_b32_e64 v23, 2, v22
    v_lshl_add_u32 v174, v23, 5, v21
    v_xor_b32_e64 v23, 3, v22
    v_lshl_add_u32 v16, v23, 5, v21
    v_lshlrev_b32 v169, 6, v162
    v_lshrrev_b32 v166, 2, v162
    v_and_b32 v166, 2, v166
    v_xor_b32 v166, v166, v163
    v_lshl_add_u32 v169, v166, 4, v169
    s_lshl_b32 s3, s6, 14
    v_add_u32 v169, s3, v169
    v_and_b32 v166, 1, v163
    v_lshlrev_b32 v166, 7, v166
    v_add_u32 v17, 131072, v17
    v_xor_b32_e64 v171, v17, v166
    v_xor_b32 v17, 128, v171
    v_mov_b32 v24, 0x3f803f80
    v_mov_b32 v25, 0x3f803f80
    v_mov_b32 v26, 0x3f803f80
    v_mov_b32 v27, 0x3f803f80
    v_and_b32 v166, 1, v161
    v_lshlrev_b32 v166, 4, v166
    v_mov_b32 v167, 0x3f80
    v_lshlrev_b32_e64 v166, v166, v167
    v_cmp_eq_u32 s[34:35], v18, v163
    v_bfe_u32 v167, v161, 1, 1
    v_cmp_eq_u32 vcc, 0, v167
    s_and_b64 s[42:43], s[34:35], vcc
    s_andn2_b64 s[36:37], s[34:35], vcc
    v_mov_b32 v152, 0
    v_mov_b32_e64 v153, 0
    v_cndmask_b32 v154, 0, v166, s[42:43]
    v_cndmask_b32 v155, 0, v166, s[36:37]
    v_mov_b32_e64 v156, 0
    v_mov_b32 v157, 0
    s_mov_b32 s29, 2
K1_x2:
    s_mov_b32 m0, s81
    s_add_u32 s3, s79, s80
    buffer_load_dwordx4 v165, s[16:19], s3 offen lds
    s_add_u32 m0, s81, 960
    s_add_u32 s79, s79, 128
    buffer_load_dwordx4 v165, s[16:19], s3 offen offset:64 lds
    s_and_b32 s79, s79, 0x3ff
    s_add_u32 s81, s81, 2048
    s_add_u32 s29, s29, 1
    s_cmp_lt_u32 s29, 8
    s_cbranch_scc1 K1_x2
    s_waitcnt lgkmcnt(0)
    s_add_u32 s58, s58, 1
    s_barrier
    s_waitcnt vmcnt(14)
    ds_read_b128 v[32:35], v169 offset:0
    ds_read_b128 v[36:39], v169 offset:1024
    s_waitcnt vmcnt(12)
    ds_read_b128 v[40:43], v169 offset:2048
    ds_read_b128 v[44:47], v169 offset:3072
    s_waitcnt vmcnt(10)
    ds_read_b128 v[48:51], v169 offset:4096
    ds_read_b128 v[52:55], v169 offset:5120
    s_waitcnt lgkmcnt(4)
    v_mfma_f32_16x16x32_bf16 v[96:99], v[24:27], v[32:35], 0
    v_mfma_f32_16x16x32_bf16 v[100:103], v[32:35], v[32:35], 0
    v_mfma_f32_16x16x32_bf16 v[96:99], v[24:27], v[36:39], v[96:99]
    v_mfma_f32_16x16x32_bf16 v[100:103], v[36:39], v[36:39], v[100:103]
    s_waitcnt vmcnt(8)
    ds_read_b128 v[56:59], v169 offset:6144
    ds_read_b128 v[60:63], v169 offset:7168
    s_waitcnt lgkmcnt(4)
    v_mfma_f32_16x16x32_bf16 v[96:99], v[24:27], v[40:43], v[96:99]
    v_mfma_f32_16x16x32_bf16 v[100:103], v[40:43], v[40:43], v[100:103]
    v_mfma_f32_16x16x32_bf16 v[96:99], v[24:27], v[44:47], v[96:99]
    v_mfma_f32_16x16x32_bf16 v[100:103], v[44:47], v[44:47], v[100:103]
    s_waitcnt vmcnt(6)
    ds_read_b128 v[64:67], v169 offset:8192
    ds_read_b128 v[68:71], v169 offset:9216
    s_waitcnt lgkmcnt(4)
    v_mfma_f32_16x16x32_bf16 v[96:99], v[24:27], v[48:51], v[96:99]
    v_mfma_f32_16x16x32_bf16 v[100:103], v[48:51], v[48:51], v[100:103]
    v_mfma_f32_16x16x32_bf16 v[96:99], v[24:27], v[52:55], v[96:99]
    v_mfma_f32_16x16x32_bf16 v[100:103], v[52:55], v[52:55], v[100:103]
    s_waitcnt vmcnt(4)
    ds_read_b128 v[72:75], v169 offset:10240
    ds_read_b128 v[76:79], v169 offset:11264
    s_waitcnt lgkmcnt(4)
    v_mfma_f32_16x16x32_bf16 v[96:99], v[24:27], v[56:59], v[96:99]
    v_mfma_f32_16x16x32_bf16 v[100:103], v[56:59], v[56:59], v[100:103]
    v_mfma_f32_16x16x32_bf16 v[96:99], v[24:27], v[60:63], v[96:99]
    v_mfma_f32_16x16x32_bf16 v[100:103], v[60:63], v[60:63], v[100:103]
    s_waitcnt vmcnt(2)
    ds_read_b128 v[80:83], v169 offset:12288
    ds_read_b128 v[84:87], v169 offset:13312
    s_waitcnt lgkmcnt(4)
    v_mfma_f32_16x16x32_bf16 v[96:99], v[24:27], v[64:67], v[96:99]
    v_mfma_f32_16x16x32_bf16 v[100:103], v[64:67], v[64:67], v[100:103]
    v_mfma_f32_16x16x32_bf16 v[96:99], v[24:27], v[68:71], v[96:99]
    v_mfma_f32_16x16x32_bf16 v[100:103], v[68:71], v[68:71], v[100:103]
    s_waitcnt vmcnt(0)
    ds_read_b128 v[88:91], v169 offset:14336
    ds_read_b128 v[92:95], v169 offset:15360
    s_waitcnt lgkmcnt(4)
    v_mfma_f32_16x16x32_bf16 v[96:99], v[24:27], v[72:75], v[96:99]
    v_mfma_f32_16x16x32_bf16 v[100:103], v[72:75], v[72:75], v[100:103]
    v_mfma_f32_16x16x32_bf16 v[96:99], v[24:27], v[76:79], v[96:99]
    v_mfma_f32_16x16x32_bf16 v[100:103], v[76:79], v[76:79], v[100:103]
    s_waitcnt lgkmcnt(2)
    v_mfma_f32_16x16x32_bf16 v[96:99], v[24:27], v[80:83], v[96:99]
    v_mfma_f32_16x16x32_bf16 v[100:103], v[80:83], v[80:83], v[100:103]
    v_mfma_f32_16x16x32_bf16 v[96:99], v[24:27], v[84:87], v[96:99]
    v_mfma_f32_16x16x32_bf16 v[100:103], v[84:87], v[84:87], v[100:103]
    s_waitcnt lgkmcnt(0)
    v_mfma_f32_16x16x32_bf16 v[96:99], v[24:27], v[88:91], v[96:99]
    v_mfma_f32_16x16x32_bf16 v[100:103], v[88:91], v[88:91], v[100:103]
    v_mfma_f32_16x16x32_bf16 v[96:99], v[24:27], v[92:95], v[96:99]
    v_mfma_f32_16x16x32_bf16 v[100:103], v[92:95], v[92:95], v[100:103]
    s_barrier
    s_lshr_b32 s79, s28, 1
    s_cmp_lg_u32 s79, s6
    s_cbranch_scc1 K1_nokvf
    ds_read_b64_tr_b16 v[184:185], v171 offset:0
    ds_read_b64_tr_b16 v[186:187], v17 offset:0
    ds_read_b64_tr_b16 v[188:189], v171 offset:1024
    ds_read_b64_tr_b16 v[190:191], v17 offset:1024
    ds_read_b64_tr_b16 v[192:193], v171 offset:2048
    ds_read_b64_tr_b16 v[194:195], v17 offset:2048
    ds_read_b64_tr_b16 v[196:197], v171 offset:3072
    ds_read_b64_tr_b16 v[198:199], v17 offset:3072
    ds_read_b64_tr_b16 v[200:201], v171 offset:4096
    ds_read_b64_tr_b16 v[202:203], v17 offset:4096
    ds_read_b64_tr_b16 v[204:205], v171 offset:5120
    ds_read_b64_tr_b16 v[206:207], v17 offset:5120
    ds_read_b64_tr_b16 v[208:209], v171 offset:6144
    ds_read_b64_tr_b16 v[210:211], v17 offset:6144
    ds_read_b64_tr_b16 v[212:213], v171 offset:7168
    ds_read_b64_tr_b16 v[214:215], v17 offset:7168
    ds_read_b64_tr_b16 v[216:217], v171 offset:8192
    ds_read_b64_tr_b16 v[218:219], v17 offset:8192
    ds_read_b64_tr_b16 v[220:221], v171 offset:9216
    ds_read_b64_tr_b16 v[222:223], v17 offset:9216
    ds_read_b64_tr_b16 v[224:225], v171 offset:10240
    ds_read_b64_tr_b16 v[226:227], v17 offset:10240
    ds_read_b64_tr_b16 v[228:229], v171 offset:11264
    ds_read_b64_tr_b16 v[230:231], v17 offset:11264
    ds_read_b64_tr_b16 v[232:233], v171 offset:12288
    ds_read_b64_tr_b16 v[234:235], v17 offset:12288
    ds_read_b64_tr_b16 v[236:237], v171 offset:13312
    ds_read_b64_tr_b16 v[238:239], v17 offset:13312
    ds_read_b64_tr_b16 v[240:241], v171 offset:14336
    ds_read_b64_tr_b16 v[242:243], v17 offset:14336
    ds_read_b64_tr_b16 v[244:245], v171 offset:15360
    ds_read_b64_tr_b16 v[246:247], v17 offset:15360
K1_nokvf:
    v_and_b32_e64 v166, 1, v161
    v_cmp_eq_u32 vcc, 1, v166
    s_nop 1
    v_cndmask_b32 v167, v100, v101, vcc
    v_cndmask_b32 v168, v102, v103, vcc
    v_cndmask_b32 v167, 0, v167, s[42:43]
    v_cndmask_b32 v26, v167, v168, s[36:37]
    v_mov_b32 v28, v26
    s_nop 1
    v_permlane16_swap_b32 v28, v26
    v_add_f32 v26, v26, v28
    v_mov_b32 v28, v26
    s_nop 1
    v_permlane32_swap_b32 v28, v26
    v_add_f32 v26, v26, v28
    v_mul_f32 v27, 0x3b000000, v96
    v_mul_f32 v29, 0x3b000000, v26
    v_fma_f32 v29, -v27, v27, v29
    v_max_f32_e64 v29, 0, v29
    v_cvt_pk_bf16_f32 v28, 0, v27
    v_cvt_pk_bf16_f32 v29, 0, v29
    v_add_f32 v29, 0x3727c5ac, v29
    v_cvt_pk_bf16_f32 v29, 0, v29
    v_sqrt_f32 v29, v29
    s_nop 0
    v_cvt_pk_bf16_f32 v29, 0, v29
    v_rcp_f32 v30, v29
    v_sub_f32 v248, 0, v28
    v_sub_f32 v249, 0, v28
    v_sub_f32 v250, 0, v28
    v_sub_f32 v251, 0, v28
    s_nop 1
    v_mfma_f32_16x16x16bf16_1k v[116:119], v[154:155], v[32:33], v[248:251]
    v_mfma_f32_16x16x16bf16_1k v[120:123], v[154:155], v[34:35], v[248:251]
    v_mfma_f32_16x16x16bf16_1k v[124:127], v[154:155], v[36:37], v[248:251]
    v_mfma_f32_16x16x16bf16_1k v[128:131], v[154:155], v[38:39], v[248:251]
    s_nop 4
    s_nop 0
    v_cvt_pk_bf16_f32 v116, 0, v116
    v_cvt_pk_bf16_f32 v117, 0, v117
    v_cvt_pk_bf16_f32 v118, 0, v118
    v_cvt_pk_bf16_f32 v119, 0, v119
    v_mfma_f32_16x16x16bf16_1k v[132:135], v[154:155], v[40:41], v[248:251]
    v_cvt_pk_bf16_f32 v120, 0, v120
    v_cvt_pk_bf16_f32 v121, 0, v121
    v_cvt_pk_bf16_f32 v122, 0, v122
    v_cvt_pk_bf16_f32 v123, 0, v123
    v_pk_mul_f32 v[116:117], v[116:117], v[30:31] op_sel_hi:[1,0]
    v_pk_mul_f32 v[118:119], v[118:119], v[30:31] op_sel_hi:[1,0]
    v_pk_mul_f32 v[120:121], v[120:121], v[30:31] op_sel_hi:[1,0]
    v_pk_mul_f32 v[122:123], v[122:123], v[30:31] op_sel_hi:[1,0]
    v_mfma_f32_16x16x16bf16_1k v[136:139], v[154:155], v[42:43], v[248:251]
    v_cvt_pk_bf16_f32 v32, v116, v117
    v_cvt_pk_bf16_f32 v33, v118, v119
    v_cvt_pk_bf16_f32 v34, v120, v121
    v_cvt_pk_bf16_f32 v35, v122, v123
    v_cvt_pk_bf16_f32 v124, 0, v124
    v_cvt_pk_bf16_f32 v125, 0, v125
    v_cvt_pk_bf16_f32 v126, 0, v126
    v_cvt_pk_bf16_f32 v127, 0, v127
    v_mfma_f32_16x16x16bf16_1k v[140:143], v[154:155], v[44:45], v[248:251]
    v_cvt_pk_bf16_f32 v128, 0, v128
    v_cvt_pk_bf16_f32 v129, 0, v129
    v_cvt_pk_bf16_f32 v130, 0, v130
    v_cvt_pk_bf16_f32 v131, 0, v131
    v_pk_mul_f32 v[124:125], v[124:125], v[30:31] op_sel_hi:[1,0]
    v_pk_mul_f32 v[126:127], v[126:127], v[30:31] op_sel_hi:[1,0]
    v_pk_mul_f32 v[128:129], v[128:129], v[30:31] op_sel_hi:[1,0]
    v_pk_mul_f32 v[130:131], v[130:131], v[30:31] op_sel_hi:[1,0]
    v_mfma_f32_16x16x16bf16_1k v[144:147], v[154:155], v[46:47], v[248:251]
    v_cvt_pk_bf16_f32 v36, v124, v125
    v_cvt_pk_bf16_f32 v37, v126, v127
    v_cvt_pk_bf16_f32 v38, v128, v129
    v_cvt_pk_bf16_f32 v39, v130, v131
    v_cvt_pk_bf16_f32 v132, 0, v132
    v_cvt_pk_bf16_f32 v133, 0, v133
    v_cvt_pk_bf16_f32 v134, 0, v134
    v_cvt_pk_bf16_f32 v135, 0, v135
    v_mfma_f32_16x16x16bf16_1k v[116:119], v[154:155], v[48:49], v[248:251]
    v_cvt_pk_bf16_f32 v136, 0, v136
    v_cvt_pk_bf16_f32 v137, 0, v137
    v_cvt_pk_bf16_f32 v138, 0, v138
    v_cvt_pk_bf16_f32 v139, 0, v139
    v_pk_mul_f32 v[132:133], v[132:133], v[30:31] op_sel_hi:[1,0]
    v_pk_mul_f32 v[134:135], v[134:135], v[30:31] op_sel_hi:[1,0]
    v_pk_mul_f32 v[136:137], v[136:137], v[30:31] op_sel_hi:[1,0]
    v_pk_mul_f32 v[138:139], v[138:139], v[30:31] op_sel_hi:[1,0]
    v_mfma_f32_16x16x16bf16_1k v[120:123], v[154:155], v[50:51], v[248:251]
    v_cvt_pk_bf16_f32 v40, v132, v133
    v_cvt_pk_bf16_f32 v41, v134, v135
    v_cvt_pk_bf16_f32 v42, v136, v137
    v_cvt_pk_bf16_f32 v43, v138, v139
    v_cvt_pk_bf16_f32 v140, 0, v140
    v_cvt_pk_bf16_f32 v141, 0, v141
    v_cvt_pk_bf16_f32 v142, 0, v142
    v_cvt_pk_bf16_f32 v143, 0, v143
    v_mfma_f32_16x16x16bf16_1k v[124:127], v[154:155], v[52:53], v[248:251]
    v_cvt_pk_bf16_f32 v144, 0, v144
    v_cvt_pk_bf16_f32 v145, 0, v145
    v_cvt_pk_bf16_f32 v146, 0, v146
    v_cvt_pk_bf16_f32 v147, 0, v147
    v_pk_mul_f32 v[140:141], v[140:141], v[30:31] op_sel_hi:[1,0]
    v_pk_mul_f32 v[142:143], v[142:143], v[30:31] op_sel_hi:[1,0]
    v_pk_mul_f32 v[144:145], v[144:145], v[30:31] op_sel_hi:[1,0]
    v_pk_mul_f32 v[146:147], v[146:147], v[30:31] op_sel_hi:[1,0]
    v_mfma_f32_16x16x16bf16_1k v[128:131], v[154:155], v[54:55], v[248:251]
    v_cvt_pk_bf16_f32 v44, v140, v141
    v_cvt_pk_bf16_f32 v45, v142, v143
    v_cvt_pk_bf16_f32 v46, v144, v145
    v_cvt_pk_bf16_f32 v47, v146, v147
    v_cvt_pk_bf16_f32 v116, 0, v116
    v_cvt_pk_bf16_f32 v117, 0, v117
    v_cvt_pk_bf16_f32 v118, 0, v118
    v_cvt_pk_bf16_f32 v119, 0, v119
    v_mfma_f32_16x16x16bf16_1k v[132:135], v[154:155], v[56:57], v[248:251]
    v_cvt_pk_bf16_f32 v120, 0, v120
    v_cvt_pk_bf16_f32 v121, 0, v121
    v_cvt_pk_bf16_f32 v122, 0, v122
    v_cvt_pk_bf16_f32 v123, 0, v123
    v_pk_mul_f32 v[116:117], v[116:117], v[30:31] op_sel_hi:[1,0]
    v_pk_mul_f32 v[118:119], v[118:119], v[30:31] op_sel_hi:[1,0]
    v_pk_mul_f32 v[120:121], v[120:121], v[30:31] op_sel_hi:[1,0]
    v_pk_mul_f32 v[122:123], v[122:123], v[30:31] op_sel_hi:[1,0]
    v_mfma_f32_16x16x16bf16_1k v[136:139], v[154:155], v[58:59], v[248:251]
    v_cvt_pk_bf16_f32 v48, v116, v117
    v_cvt_pk_bf16_f32 v49, v118, v119
    v_cvt_pk_bf16_f32 v50, v120, v121
    v_cvt_pk_bf16_f32 v51, v122, v123
    v_cvt_pk_bf16_f32 v124, 0, v124
    v_cvt_pk_bf16_f32 v125, 0, v125
    v_cvt_pk_bf16_f32 v126, 0, v126
    v_cvt_pk_bf16_f32 v127, 0, v127
    v_mfma_f32_16x16x16bf16_1k v[140:143], v[154:155], v[60:61], v[248:251]
    v_cvt_pk_bf16_f32 v128, 0, v128
    v_cvt_pk_bf16_f32 v129, 0, v129
    v_cvt_pk_bf16_f32 v130, 0, v130
    v_cvt_pk_bf16_f32 v131, 0, v131
    v_pk_mul_f32 v[124:125], v[124:125], v[30:31] op_sel_hi:[1,0]
    v_pk_mul_f32 v[126:127], v[126:127], v[30:31] op_sel_hi:[1,0]
    v_pk_mul_f32 v[128:129], v[128:129], v[30:31] op_sel_hi:[1,0]
    v_pk_mul_f32 v[130:131], v[130:131], v[30:31] op_sel_hi:[1,0]
    v_mfma_f32_16x16x16bf16_1k v[144:147], v[154:155], v[62:63], v[248:251]
    v_cvt_pk_bf16_f32 v52, v124, v125
    v_cvt_pk_bf16_f32 v53, v126, v127
    v_cvt_pk_bf16_f32 v54, v128, v129
    v_cvt_pk_bf16_f32 v55, v130, v131
    v_cvt_pk_bf16_f32 v132, 0, v132
    v_cvt_pk_bf16_f32 v133, 0, v133
    v_cvt_pk_bf16_f32 v134, 0, v134
    v_cvt_pk_bf16_f32 v135, 0, v135
    v_mfma_f32_16x16x16bf16_1k v[116:119], v[154:155], v[64:65], v[248:251]
    v_cvt_pk_bf16_f32 v136, 0, v136
    v_cvt_pk_bf16_f32 v137, 0, v137
    v_cvt_pk_bf16_f32 v138, 0, v138
    v_cvt_pk_bf16_f32 v139, 0, v139
    v_pk_mul_f32 v[132:133], v[132:133], v[30:31] op_sel_hi:[1,0]
    v_pk_mul_f32 v[134:135], v[134:135], v[30:31] op_sel_hi:[1,0]
    v_pk_mul_f32 v[136:137], v[136:137], v[30:31] op_sel_hi:[1,0]
    v_pk_mul_f32 v[138:139], v[138:139], v[30:31] op_sel_hi:[1,0]
    v_mfma_f32_16x16x16bf16_1k v[120:123], v[154:155], v[66:67], v[248:251]
    v_cvt_pk_bf16_f32 v56, v132, v133
    v_cvt_pk_bf16_f32 v57, v134, v135
    v_cvt_pk_bf16_f32 v58, v136, v137
    v_cvt_pk_bf16_f32 v59, v138, v139
    v_cvt_pk_bf16_f32 v140, 0, v140
    v_cvt_pk_bf16_f32 v141, 0, v141
    v_cvt_pk_bf16_f32 v142, 0, v142
    v_cvt_pk_bf16_f32 v143, 0, v143
    v_mfma_f32_16x16x16bf16_1k v[124:127], v[154:155], v[68:69], v[248:251]
    v_cvt_pk_bf16_f32 v144, 0, v144
    v_cvt_pk_bf16_f32 v145, 0, v145
    v_cvt_pk_bf16_f32 v146, 0, v146
    v_cvt_pk_bf16_f32 v147, 0, v147
    v_pk_mul_f32 v[140:141], v[140:141], v[30:31] op_sel_hi:[1,0]
    v_pk_mul_f32 v[142:143], v[142:143], v[30:31] op_sel_hi:[1,0]
    v_pk_mul_f32 v[144:145], v[144:145], v[30:31] op_sel_hi:[1,0]
    v_pk_mul_f32 v[146:147], v[146:147], v[30:31] op_sel_hi:[1,0]
    v_mfma_f32_16x16x16bf16_1k v[128:131], v[154:155], v[70:71], v[248:251]
    v_cvt_pk_bf16_f32 v60, v140, v141
    v_cvt_pk_bf16_f32 v61, v142, v143
    v_cvt_pk_bf16_f32 v62, v144, v145
    v_cvt_pk_bf16_f32 v63, v146, v147
    v_cvt_pk_bf16_f32 v116, 0, v116
    v_cvt_pk_bf16_f32 v117, 0, v117
    v_cvt_pk_bf16_f32 v118, 0, v118
    v_cvt_pk_bf16_f32 v119, 0, v119
    v_mfma_f32_16x16x16bf16_1k v[132:135], v[154:155], v[72:73], v[248:251]
    v_cvt_pk_bf16_f32 v120, 0, v120
    v_cvt_pk_bf16_f32 v121, 0, v121
    v_cvt_pk_bf16_f32 v122, 0, v122
    v_cvt_pk_bf16_f32 v123, 0, v123
    v_pk_mul_f32 v[116:117], v[116:117], v[30:31] op_sel_hi:[1,0]
    v_pk_mul_f32 v[118:119], v[118:119], v[30:31] op_sel_hi:[1,0]
    v_pk_mul_f32 v[120:121], v[120:121], v[30:31] op_sel_hi:[1,0]
    v_pk_mul_f32 v[122:123], v[122:123], v[30:31] op_sel_hi:[1,0]
    v_mfma_f32_16x16x16bf16_1k v[136:139], v[154:155], v[74:75], v[248:251]
    v_cvt_pk_bf16_f32 v64, v116, v117
    v_cvt_pk_bf16_f32 v65, v118, v119
    v_cvt_pk_bf16_f32 v66, v120, v121
    v_cvt_pk_bf16_f32 v67, v122, v123
    v_cvt_pk_bf16_f32 v124, 0, v124
    v_cvt_pk_bf16_f32 v125, 0, v125
    v_cvt_pk_bf16_f32 v126, 0, v126
    v_cvt_pk_bf16_f32 v127, 0, v127
    v_mfma_f32_16x16x16bf16_1k v[140:143], v[154:155], v[76:77], v[248:251]
    v_cvt_pk_bf16_f32 v128, 0, v128
    v_cvt_pk_bf16_f32 v129, 0, v129
    v_cvt_pk_bf16_f32 v130, 0, v130
    v_cvt_pk_bf16_f32 v131, 0, v131
    v_pk_mul_f32 v[124:125], v[124:125], v[30:31] op_sel_hi:[1,0]
    v_pk_mul_f32 v[126:127], v[126:127], v[30:31] op_sel_hi:[1,0]
    v_pk_mul_f32 v[128:129], v[128:129], v[30:31] op_sel_hi:[1,0]
    v_pk_mul_f32 v[130:131], v[130:131], v[30:31] op_sel_hi:[1,0]
    v_mfma_f32_16x16x16bf16_1k v[144:147], v[154:155], v[78:79], v[248:251]
    v_cvt_pk_bf16_f32 v68, v124, v125
    v_cvt_pk_bf16_f32 v69, v126, v127
    v_cvt_pk_bf16_f32 v70, v128, v129
    v_cvt_pk_bf16_f32 v71, v130, v131
    v_cvt_pk_bf16_f32 v132, 0, v132
    v_cvt_pk_bf16_f32 v133, 0, v133
    v_cvt_pk_bf16_f32 v134, 0, v134
    v_cvt_pk_bf16_f32 v135, 0, v135
    v_mfma_f32_16x16x16bf16_1k v[116:119], v[154:155], v[80:81], v[248:251]
    v_cvt_pk_bf16_f32 v136, 0, v136
    v_cvt_pk_bf16_f32 v137, 0, v137
    v_cvt_pk_bf16_f32 v138, 0, v138
    v_cvt_pk_bf16_f32 v139, 0, v139
    v_pk_mul_f32 v[132:133], v[132:133], v[30:31] op_sel_hi:[1,0]
    v_pk_mul_f32 v[134:135], v[134:135], v[30:31] op_sel_hi:[1,0]
    v_pk_mul_f32 v[136:137], v[136:137], v[30:31] op_sel_hi:[1,0]
    v_pk_mul_f32 v[138:139], v[138:139], v[30:31] op_sel_hi:[1,0]
    v_mfma_f32_16x16x16bf16_1k v[120:123], v[154:155], v[82:83], v[248:251]
    v_cvt_pk_bf16_f32 v72, v132, v133
    v_cvt_pk_bf16_f32 v73, v134, v135
    v_cvt_pk_bf16_f32 v74, v136, v137
    v_cvt_pk_bf16_f32 v75, v138, v139
    v_cvt_pk_bf16_f32 v140, 0, v140
    v_cvt_pk_bf16_f32 v141, 0, v141
    v_cvt_pk_bf16_f32 v142, 0, v142
    v_cvt_pk_bf16_f32 v143, 0, v143
    v_mfma_f32_16x16x16bf16_1k v[124:127], v[154:155], v[84:85], v[248:251]
    v_cvt_pk_bf16_f32 v144, 0, v144
    v_cvt_pk_bf16_f32 v145, 0, v145
    v_cvt_pk_bf16_f32 v146, 0, v146
    v_cvt_pk_bf16_f32 v147, 0, v147
    v_pk_mul_f32 v[140:141], v[140:141], v[30:31] op_sel_hi:[1,0]
    v_pk_mul_f32 v[142:143], v[142:143], v[30:31] op_sel_hi:[1,0]
    v_pk_mul_f32 v[144:145], v[144:145], v[30:31] op_sel_hi:[1,0]
    v_pk_mul_f32 v[146:147], v[146:147], v[30:31] op_sel_hi:[1,0]
    v_mfma_f32_16x16x16bf16_1k v[128:131], v[154:155], v[86:87], v[248:251]
    v_cvt_pk_bf16_f32 v76, v140, v141
    v_cvt_pk_bf16_f32 v77, v142, v143
    v_cvt_pk_bf16_f32 v78, v144, v145
    v_cvt_pk_bf16_f32 v79, v146, v147
    v_cvt_pk_bf16_f32 v116, 0, v116
    v_cvt_pk_bf16_f32 v117, 0, v117
    v_cvt_pk_bf16_f32 v118, 0, v118
    v_cvt_pk_bf16_f32 v119, 0, v119
    v_mfma_f32_16x16x16bf16_1k v[132:135], v[154:155], v[88:89], v[248:251]
    v_cvt_pk_bf16_f32 v120, 0, v120
    v_cvt_pk_bf16_f32 v121, 0, v121
    v_cvt_pk_bf16_f32 v122, 0, v122
    v_cvt_pk_bf16_f32 v123, 0, v123
    v_pk_mul_f32 v[116:117], v[116:117], v[30:31] op_sel_hi:[1,0]
    v_pk_mul_f32 v[118:119], v[118:119], v[30:31] op_sel_hi:[1,0]
    v_pk_mul_f32 v[120:121], v[120:121], v[30:31] op_sel_hi:[1,0]
    v_pk_mul_f32 v[122:123], v[122:123], v[30:31] op_sel_hi:[1,0]
    v_mfma_f32_16x16x16bf16_1k v[136:139], v[154:155], v[90:91], v[248:251]
    v_cvt_pk_bf16_f32 v80, v116, v117
    v_cvt_pk_bf16_f32 v81, v118, v119
    v_cvt_pk_bf16_f32 v82, v120, v121
    v_cvt_pk_bf16_f32 v83, v122, v123
    v_cvt_pk_bf16_f32 v124, 0, v124
    v_cvt_pk_bf16_f32 v125, 0, v125
    v_cvt_pk_bf16_f32 v126, 0, v126
    v_cvt_pk_bf16_f32 v127, 0, v127
    v_mfma_f32_16x16x16bf16_1k v[140:143], v[154:155], v[92:93], v[248:251]
    v_cvt_pk_bf16_f32 v128, 0, v128
    v_cvt_pk_bf16_f32 v129, 0, v129
    v_cvt_pk_bf16_f32 v130, 0, v130
    v_cvt_pk_bf16_f32 v131, 0, v131
    v_pk_mul_f32 v[124:125], v[124:125], v[30:31] op_sel_hi:[1,0]
    v_pk_mul_f32 v[126:127], v[126:127], v[30:31] op_sel_hi:[1,0]
    v_pk_mul_f32 v[128:129], v[128:129], v[30:31] op_sel_hi:[1,0]
    v_pk_mul_f32 v[130:131], v[130:131], v[30:31] op_sel_hi:[1,0]
    v_mfma_f32_16x16x16bf16_1k v[144:147], v[154:155], v[94:95], v[248:251]
    v_cvt_pk_bf16_f32 v84, v124, v125
    v_cvt_pk_bf16_f32 v85, v126, v127
    v_cvt_pk_bf16_f32 v86, v128, v129
    v_cvt_pk_bf16_f32 v87, v130, v131
    v_cvt_pk_bf16_f32 v132, 0, v132
    v_cvt_pk_bf16_f32 v133, 0, v133
    v_cvt_pk_bf16_f32 v134, 0, v134
    v_cvt_pk_bf16_f32 v135, 0, v135
    v_cvt_pk_bf16_f32 v136, 0, v136
    v_cvt_pk_bf16_f32 v137, 0, v137
    v_cvt_pk_bf16_f32 v138, 0, v138
    v_cvt_pk_bf16_f32 v139, 0, v139
    v_pk_mul_f32 v[132:133], v[132:133], v[30:31] op_sel_hi:[1,0]
    v_pk_mul_f32 v[134:135], v[134:135], v[30:31] op_sel_hi:[1,0]
    v_pk_mul_f32 v[136:137], v[136:137], v[30:31] op_sel_hi:[1,0]
    v_pk_mul_f32 v[138:139], v[138:139], v[30:31] op_sel_hi:[1,0]
    v_cvt_pk_bf16_f32 v88, v132, v133
    v_cvt_pk_bf16_f32 v89, v134, v135
    v_cvt_pk_bf16_f32 v90, v136, v137
    v_cvt_pk_bf16_f32 v91, v138, v139
    v_cvt_pk_bf16_f32 v140, 0, v140
    v_cvt_pk_bf16_f32 v141, 0, v141
    v_cvt_pk_bf16_f32 v142, 0, v142
    v_cvt_pk_bf16_f32 v143, 0, v143
    v_cvt_pk_bf16_f32 v144, 0, v144
    v_cvt_pk_bf16_f32 v145, 0, v145
    v_cvt_pk_bf16_f32 v146, 0, v146
    v_cvt_pk_bf16_f32 v147, 0, v147
    v_pk_mul_f32 v[140:141], v[140:141], v[30:31] op_sel_hi:[1,0]
    v_pk_mul_f32 v[142:143], v[142:143], v[30:31] op_sel_hi:[1,0]
    v_pk_mul_f32 v[144:145], v[144:145], v[30:31] op_sel_hi:[1,0]
    v_pk_mul_f32 v[146:147], v[146:147], v[30:31] op_sel_hi:[1,0]
    v_cvt_pk_bf16_f32 v92, v140, v141
    v_cvt_pk_bf16_f32 v93, v142, v143
    v_cvt_pk_bf16_f32 v94, v144, v145
    v_cvt_pk_bf16_f32 v95, v146, v147
    v_lshrrev_b32_e64 v168, 1, v163
    v_and_b32 v170, 1, v163
    s_cmp_lg_u32 s79, s6
    s_cbranch_scc1 K1_q
    s_lshr_b32 s35, s80, 15
    s_mul_i32 s35, s35, 2176
    s_add_u32 s35, s35, 0x260000
    s_waitcnt lgkmcnt(0)
    s_bitcmp0_b32 s28, 0
    s_cbranch_scc0 K1_v
    s_nop 0
    v_mfma_f32_16x16x32_bf16 v[112:115], v[184:187], v[32:35], 0
    v_mfma_f32_16x16x32_bf16 v[112:115], v[188:191], v[36:39], v[112:115]
    v_mfma_f32_16x16x32_bf16 v[112:115], v[192:195], v[40:43], v[112:115]
    v_mfma_f32_16x16x32_bf16 v[112:115], v[196:199], v[44:47], v[112:115]
    v_mfma_f32_16x16x32_bf16 v[112:115], v[200:203], v[48:51], v[112:115]
    v_mfma_f32_16x16x32_bf16 v[112:115], v[204:207], v[52:55], v[112:115]
    v_mfma_f32_16x16x32_bf16 v[112:115], v[208:211], v[56:59], v[112:115]
    v_mfma_f32_16x16x32_bf16 v[112:115], v[212:215], v[60:63], v[112:115]
    v_mfma_f32_16x16x32_bf16 v[112:115], v[216:219], v[64:67], v[112:115]
    v_mfma_f32_16x16x32_bf16 v[112:115], v[220:223], v[68:71], v[112:115]
    v_mfma_f32_16x16x32_bf16 v[112:115], v[224:227], v[72:75], v[112:115]
    v_mfma_f32_16x16x32_bf16 v[112:115], v[228:231], v[76:79], v[112:115]
    v_mfma_f32_16x16x32_bf16 v[112:115], v[232:235], v[80:83], v[112:115]
    v_mfma_f32_16x16x32_bf16 v[112:115], v[236:239], v[84:87], v[112:115]
    v_mfma_f32_16x16x32_bf16 v[112:115], v[240:243], v[88:91], v[112:115]
    v_mfma_f32_16x16x32_bf16 v[112:115], v[244:247], v[92:95], v[112:115]
    v_and_b32 v167, 31, v164
    v_lshlrev_b32 v167, 4, v167
    v_lshl_add_u32 v167, v168, 9, v167
    s_branch K1_kvs
K1_v:
    s_nop 0
    v_mfma_f32_16x16x32_bf16 v[112:115], v[32:35], v[184:187], 0
    v_mfma_f32_16x16x32_bf16 v[112:115], v[36:39], v[188:191], v[112:115]
    v_mfma_f32_16x16x32_bf16 v[112:115], v[40:43], v[192:195], v[112:115]
    v_mfma_f32_16x16x32_bf16 v[112:115], v[44:47], v[196:199], v[112:115]
    v_mfma_f32_16x16x32_bf16 v[112:115], v[48:51], v[200:203], v[112:115]
    v_mfma_f32_16x16x32_bf16 v[112:115], v[52:55], v[204:207], v[112:115]
    v_mfma_f32_16x16x32_bf16 v[112:115], v[56:59], v[208:211], v[112:115]
    v_mfma_f32_16x16x32_bf16 v[112:115], v[60:63], v[212:215], v[112:115]
    v_mfma_f32_16x16x32_bf16 v[112:115], v[64:67], v[216:219], v[112:115]
    v_mfma_f32_16x16x32_bf16 v[112:115], v[68:71], v[220:223], v[112:115]
    v_mfma_f32_16x16x32_bf16 v[112:115], v[72:75], v[224:227], v[112:115]
    v_mfma_f32_16x16x32_bf16 v[112:115], v[76:79], v[228:231], v[112:115]
    v_mfma_f32_16x16x32_bf16 v[112:115], v[80:83], v[232:235], v[112:115]
    v_mfma_f32_16x16x32_bf16 v[112:115], v[84:87], v[236:239], v[112:115]
    v_mfma_f32_16x16x32_bf16 v[112:115], v[88:91], v[240:243], v[112:115]
    v_mfma_f32_16x16x32_bf16 v[112:115], v[92:95], v[244:247], v[112:115]
    s_and_b32 s36, s6, 1
    s_mul_i32 s36, s36, 544
    s_add_u32 s35, s35, s36
    s_add_u32 s35, s35, 1024
    v_mul_u32_u24 v167, 272, v168
    v_lshl_add_u32 v167, v162, 4, v167
K1_kvs:
    s_nop 3
    v_cvt_pk_bf16_f32 v148, v112, v113
    v_cvt_pk_bf16_f32 v149, v114, v115
    v_mov_b32 v150, v148
    v_mov_b32 v151, v149
    s_nop 0
    v_permlane16_swap_b32 v148, v150
    v_permlane16_swap_b32 v149, v151
    v_min_u32_e64 v148, -2, v148
    s_mov_b32 exec_lo, 0xffff
    s_mov_b32 exec_hi, 0xffff
    buffer_store_dwordx4 v[148:151], v167, s[8:11], s35 offen sc1
    s_mov_b64 exec, -1
K1_q:
    s_barrier
    ds_read_b64_tr_b16 v[184:185], v172 offset:0
    ds_read_b64_tr_b16 v[186:187], v172 offset:512
    ds_read_b64_tr_b16 v[188:189], v173 offset:0
    ds_read_b64_tr_b16 v[190:191], v173 offset:512
    ds_read_b64_tr_b16 v[192:193], v174 offset:0
    ds_read_b64_tr_b16 v[194:195], v174 offset:512
    ds_read_b64_tr_b16 v[196:197], v16 offset:0
    ds_read_b64_tr_b16 v[198:199], v16 offset:512
    ds_read_b64_tr_b16 v[200:201], v172 offset:4096
    ds_read_b64_tr_b16 v[202:203], v172 offset:4608
    ds_read_b64_tr_b16 v[204:205], v173 offset:4096
    ds_read_b64_tr_b16 v[206:207], v173 offset:4608
    ds_read_b64_tr_b16 v[208:209], v174 offset:4096
    ds_read_b64_tr_b16 v[210:211], v174 offset:4608
    ds_read_b64_tr_b16 v[212:213], v16 offset:4096
    ds_read_b64_tr_b16 v[214:215], v16 offset:4608
    s_waitcnt lgkmcnt(8)
    s_nop 0
    v_mfma_f32_16x16x32_bf16 v[96:99], v[184:187], v[32:35], 0
    ds_read_b64_tr_b16 v[216:217], v172 offset:8192
    ds_read_b64_tr_b16 v[218:219], v172 offset:8704
    v_mfma_f32_16x16x32_bf16 v[100:103], v[188:191], v[32:35], 0
    ds_read_b64_tr_b16 v[220:221], v173 offset:8192
    ds_read_b64_tr_b16 v[222:223], v173 offset:8704
    v_mfma_f32_16x16x32_bf16 v[104:107], v[192:195], v[32:35], 0
    ds_read_b64_tr_b16 v[224:225], v174 offset:8192
    ds_read_b64_tr_b16 v[226:227], v174 offset:8704
    v_mfma_f32_16x16x32_bf16 v[108:111], v[196:199], v[32:35], 0
    ds_read_b64_tr_b16 v[228:229], v16 offset:8192
    ds_read_b64_tr_b16 v[230:231], v16 offset:8704
    s_waitcnt lgkmcnt(8)
    s_nop 0
    v_mfma_f32_16x16x32_bf16 v[96:99], v[200:203], v[36:39], v[96:99]
    ds_read_b64_tr_b16 v[184:185], v172 offset:12288
    ds_read_b64_tr_b16 v[186:187], v172 offset:12800
    v_mfma_f32_16x16x32_bf16 v[100:103], v[204:207], v[36:39], v[100:103]
    ds_read_b64_tr_b16 v[188:189], v173 offset:12288
    ds_read_b64_tr_b16 v[190:191], v173 offset:12800
    v_mfma_f32_16x16x32_bf16 v[104:107], v[208:211], v[36:39], v[104:107]
    ds_read_b64_tr_b16 v[192:193], v174 offset:12288
    ds_read_b64_tr_b16 v[194:195], v174 offset:12800
    v_mfma_f32_16x16x32_bf16 v[108:111], v[212:215], v[36:39], v[108:111]
    ds_read_b64_tr_b16 v[196:197], v16 offset:12288
    ds_read_b64_tr_b16 v[198:199], v16 offset:12800
    s_waitcnt lgkmcnt(8)
    s_nop 0
    v_mfma_f32_16x16x32_bf16 v[96:99], v[216:219], v[40:43], v[96:99]
    ds_read_b64_tr_b16 v[200:201], v172 offset:16384
    ds_read_b64_tr_b16 v[202:203], v172 offset:16896
    v_mfma_f32_16x16x32_bf16 v[100:103], v[220:223], v[40:43], v[100:103]
    ds_read_b64_tr_b16 v[204:205], v173 offset:16384
    ds_read_b64_tr_b16 v[206:207], v173 offset:16896
    v_mfma_f32_16x16x32_bf16 v[104:107], v[224:227], v[40:43], v[104:107]
    ds_read_b64_tr_b16 v[208:209], v174 offset:16384
    ds_read_b64_tr_b16 v[210:211], v174 offset:16896
    v_mfma_f32_16x16x32_bf16 v[108:111], v[228:231], v[40:43], v[108:111]
    ds_read_b64_tr_b16 v[212:213], v16 offset:16384
    ds_read_b64_tr_b16 v[214:215], v16 offset:16896
    s_waitcnt lgkmcnt(8)
    s_nop 0
    v_mfma_f32_16x16x32_bf16 v[96:99], v[184:187], v[44:47], v[96:99]
    ds_read_b64_tr_b16 v[216:217], v172 offset:20480
    ds_read_b64_tr_b16 v[218:219], v172 offset:20992
    v_mfma_f32_16x16x32_bf16 v[100:103], v[188:191], v[44:47], v[100:103]
    ds_read_b64_tr_b16 v[220:221], v173 offset:20480
    ds_read_b64_tr_b16 v[222:223], v173 offset:20992
    v_mfma_f32_16x16x32_bf16 v[104:107], v[192:195], v[44:47], v[104:107]
    ds_read_b64_tr_b16 v[224:225], v174 offset:20480
    ds_read_b64_tr_b16 v[226:227], v174 offset:20992
    v_mfma_f32_16x16x32_bf16 v[108:111], v[196:199], v[44:47], v[108:111]
    ds_read_b64_tr_b16 v[228:229], v16 offset:20480
    ds_read_b64_tr_b16 v[230:231], v16 offset:20992
    s_waitcnt lgkmcnt(8)
    s_nop 0
    v_mfma_f32_16x16x32_bf16 v[96:99], v[200:203], v[48:51], v[96:99]
    ds_read_b64_tr_b16 v[184:185], v172 offset:24576
    ds_read_b64_tr_b16 v[186:187], v172 offset:25088
    v_mfma_f32_16x16x32_bf16 v[100:103], v[204:207], v[48:51], v[100:103]
    ds_read_b64_tr_b16 v[188:189], v173 offset:24576
    ds_read_b64_tr_b16 v[190:191], v173 offset:25088
    v_mfma_f32_16x16x32_bf16 v[104:107], v[208:211], v[48:51], v[104:107]
    ds_read_b64_tr_b16 v[192:193], v174 offset:24576
    ds_read_b64_tr_b16 v[194:195], v174 offset:25088
    v_mfma_f32_16x16x32_bf16 v[108:111], v[212:215], v[48:51], v[108:111]
    ds_read_b64_tr_b16 v[196:197], v16 offset:24576
    ds_read_b64_tr_b16 v[198:199], v16 offset:25088
    s_waitcnt lgkmcnt(8)
    s_nop 0
    v_mfma_f32_16x16x32_bf16 v[96:99], v[216:219], v[52:55], v[96:99]
    ds_read_b64_tr_b16 v[200:201], v172 offset:28672
    ds_read_b64_tr_b16 v[202:203], v172 offset:29184
    v_mfma_f32_16x16x32_bf16 v[100:103], v[220:223], v[52:55], v[100:103]
    ds_read_b64_tr_b16 v[204:205], v173 offset:28672
    ds_read_b64_tr_b16 v[206:207], v173 offset:29184
    v_mfma_f32_16x16x32_bf16 v[104:107], v[224:227], v[52:55], v[104:107]
    ds_read_b64_tr_b16 v[208:209], v174 offset:28672
    ds_read_b64_tr_b16 v[210:211], v174 offset:29184
    v_mfma_f32_16x16x32_bf16 v[108:111], v[228:231], v[52:55], v[108:111]
    ds_read_b64_tr_b16 v[212:213], v16 offset:28672
    ds_read_b64_tr_b16 v[214:215], v16 offset:29184
    s_waitcnt lgkmcnt(8)
    s_nop 0
    v_mfma_f32_16x16x32_bf16 v[96:99], v[184:187], v[56:59], v[96:99]
    ds_read_b64_tr_b16 v[216:217], v172 offset:32768
    ds_read_b64_tr_b16 v[218:219], v172 offset:33280
    v_mfma_f32_16x16x32_bf16 v[100:103], v[188:191], v[56:59], v[100:103]
    ds_read_b64_tr_b16 v[220:221], v173 offset:32768
    ds_read_b64_tr_b16 v[222:223], v173 offset:33280
    v_mfma_f32_16x16x32_bf16 v[104:107], v[192:195], v[56:59], v[104:107]
    ds_read_b64_tr_b16 v[224:225], v174 offset:32768
    ds_read_b64_tr_b16 v[226:227], v174 offset:33280
    v_mfma_f32_16x16x32_bf16 v[108:111], v[196:199], v[56:59], v[108:111]
    ds_read_b64_tr_b16 v[228:229], v16 offset:32768
    ds_read_b64_tr_b16 v[230:231], v16 offset:33280
    s_waitcnt lgkmcnt(8)
    s_nop 0
    v_mfma_f32_16x16x32_bf16 v[96:99], v[200:203], v[60:63], v[96:99]
    ds_read_b64_tr_b16 v[184:185], v172 offset:36864
    ds_read_b64_tr_b16 v[186:187], v172 offset:37376
    v_mfma_f32_16x16x32_bf16 v[100:103], v[204:207], v[60:63], v[100:103]
    ds_read_b64_tr_b16 v[188:189], v173 offset:36864
    ds_read_b64_tr_b16 v[190:191], v173 offset:37376
    v_mfma_f32_16x16x32_bf16 v[104:107], v[208:211], v[60:63], v[104:107]
    ds_read_b64_tr_b16 v[192:193], v174 offset:36864
    ds_read_b64_tr_b16 v[194:195], v174 offset:37376
    v_mfma_f32_16x16x32_bf16 v[108:111], v[212:215], v[60:63], v[108:111]
    ds_read_b64_tr_b16 v[196:197], v16 offset:36864
    ds_read_b64_tr_b16 v[198:199], v16 offset:37376
    s_waitcnt lgkmcnt(8)
    s_nop 0
    v_mfma_f32_16x16x32_bf16 v[96:99], v[216:219], v[64:67], v[96:99]
    ds_read_b64_tr_b16 v[200:201], v172 offset:40960
    ds_read_b64_tr_b16 v[202:203], v172 offset:41472
    v_mfma_f32_16x16x32_bf16 v[100:103], v[220:223], v[64:67], v[100:103]
    ds_read_b64_tr_b16 v[204:205], v173 offset:40960
    ds_read_b64_tr_b16 v[206:207], v173 offset:41472
    v_mfma_f32_16x16x32_bf16 v[104:107], v[224:227], v[64:67], v[104:107]
    ds_read_b64_tr_b16 v[208:209], v174 offset:40960
    ds_read_b64_tr_b16 v[210:211], v174 offset:41472
    v_mfma_f32_16x16x32_bf16 v[108:111], v[228:231], v[64:67], v[108:111]
    ds_read_b64_tr_b16 v[212:213], v16 offset:40960
    ds_read_b64_tr_b16 v[214:215], v16 offset:41472
    s_waitcnt lgkmcnt(8)
    s_nop 0
    v_mfma_f32_16x16x32_bf16 v[96:99], v[184:187], v[68:71], v[96:99]
    ds_read_b64_tr_b16 v[216:217], v172 offset:45056
    ds_read_b64_tr_b16 v[218:219], v172 offset:45568
    v_mfma_f32_16x16x32_bf16 v[100:103], v[188:191], v[68:71], v[100:103]
    ds_read_b64_tr_b16 v[220:221], v173 offset:45056
    ds_read_b64_tr_b16 v[222:223], v173 offset:45568
    v_mfma_f32_16x16x32_bf16 v[104:107], v[192:195], v[68:71], v[104:107]
    ds_read_b64_tr_b16 v[224:225], v174 offset:45056
    ds_read_b64_tr_b16 v[226:227], v174 offset:45568
    v_mfma_f32_16x16x32_bf16 v[108:111], v[196:199], v[68:71], v[108:111]
    ds_read_b64_tr_b16 v[228:229], v16 offset:45056
    ds_read_b64_tr_b16 v[230:231], v16 offset:45568
    s_waitcnt lgkmcnt(8)
    s_nop 0
    v_mfma_f32_16x16x32_bf16 v[96:99], v[200:203], v[72:75], v[96:99]
    ds_read_b64_tr_b16 v[184:185], v172 offset:49152
    ds_read_b64_tr_b16 v[186:187], v172 offset:49664
    v_mfma_f32_16x16x32_bf16 v[100:103], v[204:207], v[72:75], v[100:103]
    ds_read_b64_tr_b16 v[188:189], v173 offset:49152
    ds_read_b64_tr_b16 v[190:191], v173 offset:49664
    v_mfma_f32_16x16x32_bf16 v[104:107], v[208:211], v[72:75], v[104:107]
    ds_read_b64_tr_b16 v[192:193], v174 offset:49152
    ds_read_b64_tr_b16 v[194:195], v174 offset:49664
    v_mfma_f32_16x16x32_bf16 v[108:111], v[212:215], v[72:75], v[108:111]
    ds_read_b64_tr_b16 v[196:197], v16 offset:49152
    ds_read_b64_tr_b16 v[198:199], v16 offset:49664
    s_waitcnt lgkmcnt(8)
    s_nop 0
    v_mfma_f32_16x16x32_bf16 v[96:99], v[216:219], v[76:79], v[96:99]
    ds_read_b64_tr_b16 v[200:201], v172 offset:53248
    ds_read_b64_tr_b16 v[202:203], v172 offset:53760
    v_mfma_f32_16x16x32_bf16 v[100:103], v[220:223], v[76:79], v[100:103]
    ds_read_b64_tr_b16 v[204:205], v173 offset:53248
    ds_read_b64_tr_b16 v[206:207], v173 offset:53760
    v_mfma_f32_16x16x32_bf16 v[104:107], v[224:227], v[76:79], v[104:107]
    ds_read_b64_tr_b16 v[208:209], v174 offset:53248
    ds_read_b64_tr_b16 v[210:211], v174 offset:53760
    v_mfma_f32_16x16x32_bf16 v[108:111], v[228:231], v[76:79], v[108:111]
    ds_read_b64_tr_b16 v[212:213], v16 offset:53248
    ds_read_b64_tr_b16 v[214:215], v16 offset:53760
    s_waitcnt lgkmcnt(8)
    s_nop 0
    v_mfma_f32_16x16x32_bf16 v[96:99], v[184:187], v[80:83], v[96:99]
    ds_read_b64_tr_b16 v[216:217], v172 offset:57344
    ds_read_b64_tr_b16 v[218:219], v172 offset:57856
    v_mfma_f32_16x16x32_bf16 v[100:103], v[188:191], v[80:83], v[100:103]
    ds_read_b64_tr_b16 v[220:221], v173 offset:57344
    ds_read_b64_tr_b16 v[222:223], v173 offset:57856
    v_mfma_f32_16x16x32_bf16 v[104:107], v[192:195], v[80:83], v[104:107]
    ds_read_b64_tr_b16 v[224:225], v174 offset:57344
    ds_read_b64_tr_b16 v[226:227], v174 offset:57856
    v_mfma_f32_16x16x32_bf16 v[108:111], v[196:199], v[80:83], v[108:111]
    ds_read_b64_tr_b16 v[228:229], v16 offset:57344
    ds_read_b64_tr_b16 v[230:231], v16 offset:57856
    s_waitcnt lgkmcnt(8)
    s_nop 0
    v_mfma_f32_16x16x32_bf16 v[96:99], v[200:203], v[84:87], v[96:99]
    ds_read_b64_tr_b16 v[184:185], v172 offset:61440
    ds_read_b64_tr_b16 v[186:187], v172 offset:61952
    v_mfma_f32_16x16x32_bf16 v[100:103], v[204:207], v[84:87], v[100:103]
    ds_read_b64_tr_b16 v[188:189], v173 offset:61440
    ds_read_b64_tr_b16 v[190:191], v173 offset:61952
    v_mfma_f32_16x16x32_bf16 v[104:107], v[208:211], v[84:87], v[104:107]
    ds_read_b64_tr_b16 v[192:193], v174 offset:61440
    ds_read_b64_tr_b16 v[194:195], v174 offset:61952
    v_mfma_f32_16x16x32_bf16 v[108:111], v[212:215], v[84:87], v[108:111]
    ds_read_b64_tr_b16 v[196:197], v16 offset:61440
    ds_read_b64_tr_b16 v[198:199], v16 offset:61952
    s_waitcnt lgkmcnt(8)
    v_mfma_f32_16x16x32_bf16 v[96:99], v[216:219], v[88:91], v[96:99]
    v_mfma_f32_16x16x32_bf16 v[100:103], v[220:223], v[88:91], v[100:103]
    v_mfma_f32_16x16x32_bf16 v[104:107], v[224:227], v[88:91], v[104:107]
    v_mfma_f32_16x16x32_bf16 v[108:111], v[228:231], v[88:91], v[108:111]
    s_waitcnt lgkmcnt(0)
    v_mfma_f32_16x16x32_bf16 v[96:99], v[184:187], v[92:95], v[96:99]
    v_mfma_f32_16x16x32_bf16 v[100:103], v[188:191], v[92:95], v[100:103]
    v_mfma_f32_16x16x32_bf16 v[104:107], v[192:195], v[92:95], v[104:107]
    v_mfma_f32_16x16x32_bf16 v[108:111], v[196:199], v[92:95], v[108:111]
    s_lshl_b32 s35, s28, 10
    s_mov_b32 s36, 0x3eb8aa3b
    v_lshrrev_b32 v166, 3, v164
    v_lshlrev_b32 v166, 13, v166
    v_and_b32 v167, 7, v164
    v_lshl_add_u32 v166, v167, 4, v166
    v_lshl_add_u32 v166, v168, 9, v166
    v_lshl_add_u32 v166, v170, 7, v166
    v_cvt_pk_bf16_f32 v96, 0, v96
    v_cvt_pk_bf16_f32 v97, 0, v97
    v_cvt_pk_bf16_f32 v98, 0, v98
    v_cvt_pk_bf16_f32 v99, 0, v99
    v_mul_f32 v96, 0x3eb8aa3b, v96
    v_mul_f32 v97, 0x3eb8aa3b, v97
    v_mul_f32 v98, 0x3eb8aa3b, v98
    v_mul_f32 v99, 0x3eb8aa3b, v99
    v_cvt_pk_bf16_f32 v116, v96, v97
    v_cvt_pk_bf16_f32 v117, v98, v99
    v_cvt_pk_bf16_f32 v100, 0, v100
    v_cvt_pk_bf16_f32 v101, 0, v101
    v_cvt_pk_bf16_f32 v102, 0, v102
    v_cvt_pk_bf16_f32 v103, 0, v103
    v_mul_f32 v100, 0x3eb8aa3b, v100
    v_mul_f32 v101, 0x3eb8aa3b, v101
    v_mul_f32 v102, 0x3eb8aa3b, v102
    v_mul_f32 v103, 0x3eb8aa3b, v103
    v_cvt_pk_bf16_f32 v118, v100, v101
    v_cvt_pk_bf16_f32 v119, v102, v103
    s_nop 0
    v_permlane16_swap_b32 v116, v118
    v_permlane16_swap_b32 v117, v119
    s_nop 0
    buffer_store_dwordx4 v[116:119], v166, s[8:11], s35 offen offset:0 sc1
    v_cvt_pk_bf16_f32 v104, 0, v104
    v_cvt_pk_bf16_f32 v105, 0, v105
    v_cvt_pk_bf16_f32 v106, 0, v106
    v_cvt_pk_bf16_f32 v107, 0, v107
    v_mul_f32 v104, 0x3eb8aa3b, v104
    v_mul_f32 v105, 0x3eb8aa3b, v105
    v_mul_f32 v106, 0x3eb8aa3b, v106
    v_mul_f32 v107, 0x3eb8aa3b, v107
    v_cvt_pk_bf16_f32 v120, v104, v105
    v_cvt_pk_bf16_f32 v121, v106, v107
    v_cvt_pk_bf16_f32 v108, 0, v108
    v_cvt_pk_bf16_f32 v109, 0, v109
    v_cvt_pk_bf16_f32 v110, 0, v110
    v_cvt_pk_bf16_f32 v111, 0, v111
    v_mul_f32 v108, 0x3eb8aa3b, v108
    v_mul_f32 v109, 0x3eb8aa3b, v109
    v_mul_f32 v110, 0x3eb8aa3b, v110
    v_mul_f32 v111, 0x3eb8aa3b, v111
    v_cvt_pk_bf16_f32 v122, v108, v109
    v_cvt_pk_bf16_f32 v123, v110, v111
    s_nop 0
    v_permlane16_swap_b32 v120, v122
    v_permlane16_swap_b32 v121, v123
    buffer_store_dwordx4 v[120:123], v166, s[8:11], s35 offen offset:256 sc1
    s_cmp_lg_u32 s79, s6
    s_cbranch_scc1 K1_nol
    v_and_b32 v167, 0x3ff, v166
    s_mov_b32 s36, 0x00ff00ff
    s_and_b32 s37, s28, 1
    s_lshl_b32 s37, s37, 3
    s_lshl_b32 exec_lo, s36, s37
    s_mov_b32 exec_hi, exec_lo
    ds_write_b128 v167, v[116:119] offset:24576
    ds_write_b128 v167, v[120:123] offset:24832
    s_mov_b64 exec, -1
K1_nol:
    s_branch K12_join
K12_setup:
    s_load_dwordx2 s[48:49], s[0:1], 96
    s_load_dwordx2 s[40:41], s[0:1], 0
    s_load_dwordx8 s[60:67], s[0:1], 48
    s_load_dwordx2 s[46:47], s[0:1], 80
    s_waitcnt lgkmcnt(0)
K12_setup1:
    s_and_b32 s3, s2, 7
    s_lshr_b32 s4, s2, 3
    s_lshl_b32 s7, s3, 8
    s_lshl_b32 s5, s4, 3
    s_add_u32 s7, s7, s5
    s_and_b32 s28, s4, 7
    v_lshrrev_b32 v11, 6, v0
    v_and_b32 v0, 63, v0
    v_readfirstlane_b32 s6, v11
    s_mov_b32 s30, 0
    v_lshlrev_b32_e64 v8, 4, v0
    s_mul_i32 s3, s6, 17408
    s_add_u32 s3, s3, 0x260000
    s_add_u32 s4, s28, 0
    s_and_b32 s4, s4, 7
    s_mul_i32 s4, s4, 2176
    s_add_u32 s50, s3, s4
    s_add_u32 s4, s28, 1
    s_and_b32 s4, s4, 7
    s_mul_i32 s4, s4, 2176
    s_add_u32 s51, s3, s4
    s_add_u32 s4, s28, 2
    s_and_b32 s4, s4, 7
    s_mul_i32 s4, s4, 2176
    s_add_u32 s52, s3, s4
    s_add_u32 s4, s28, 3
    s_and_b32 s4, s4, 7
    s_mul_i32 s4, s4, 2176
    s_add_u32 s53, s3, s4
    s_add_u32 s4, s28, 4
    s_and_b32 s4, s4, 7
    s_mul_i32 s4, s4, 2176
    s_add_u32 s54, s3, s4
    s_add_u32 s4, s28, 5
    s_and_b32 s4, s4, 7
    s_mul_i32 s4, s4, 2176
    s_add_u32 s55, s3, s4
    s_add_u32 s4, s28, 6
    s_and_b32 s4, s4, 7
    s_mul_i32 s4, s4, 2176
    s_add_u32 s56, s3, s4
    s_add_u32 s4, s28, 7
    s_and_b32 s4, s4, 7
    s_mul_i32 s4, s4, 2176
    s_add_u32 s57, s3, s4
K2_restart:
    s_add_u32 s44, s6, 4
    s_and_b32 s44, s44, 7
    s_add_u32 s3, s44, s28
    s_and_b32 s3, s3, 7
    s_andn2_b32 s45, s2, 0x38
    s_lshl_b32 s4, s3, 3
    s_or_b32 s45, s45, s4
    s_lshl_b32 s45, s45, 6
    s_lshr_b32 s4, s28, 1
    s_lshl_b32 s4, s4, 2
    s_add_u32 s45, s45, s4
    s_add_u32 s45, s45, 0x220000
    s_add_u32 s3, s3, s7
    s_lshl_b32 s32, s3, 10
    v_and_b32 v12, 31, v0
    v_lshrrev_b32_e64 v13, 5, v0
    v_mul_u32_u24 v10, 272, v13
    v_lshl_add_u32 v10, v12, 4, v10
    v_cmp_lt_u32 vcc, 16, v12
    v_bfrev_b32 v11, 1
    v_add_u32 v1, 0x6000, v8
    v_cndmask_b32 v10, v10, v11, vcc
    s_mov_b32 s8, s48
    s_mov_b32 s9, s49
    s_mov_b32 s10, 0x800000
    s_mov_b32 s11, 0x00020000
    s_lshl_b32 s3, s44, 10
    v_add_u32_e64 v15, s3, v1
    s_mov_b32 s16, s40
    s_mov_b32 s17, s41
    s_mov_b32 s18, 0x200000
    s_mov_b32 s19, 0x00020000
    s_mov_b32 s20, s46
    s_mov_b32 s21, s47
    s_mov_b32 s22, 0x200000
    s_mov_b32 s23, 0x00020000
    s_mov_b32 s24, s60
    s_mov_b32 s25, s61
    s_mov_b32 s26, 0x400
    s_mov_b32 s27, 0x00020000
    v_and_b32 v241, 31, v0
    v_lshrrev_b32 v242, 5, v0
    v_mul_u32_u24 v2, 80, v241
    s_mul_i32 s3, s6, 2560
    v_add_u32_e64 v2, s3, v2
    v_lshl_add_u32 v179, v242, 2, v2
    v_lshl_add_u32 v2, v242, 4, v2
    v_lshrrev_b32 v240, 4, v0
    s_lshr_b32 s3, s6, 1
    s_lshl_b32 s3, s3, 3
    s_and_b32 s4, s6, 1
    s_lshl_b32 s4, s4, 1
    s_add_u32 s3, s3, s4
    v_and_b32_e64 v241, 1, v240
    v_lshl_add_u32 v241, v241, 2, v242
    v_add_u32_e64 v241, s3, v241
    v_mul_u32_u24 v4, 80, v241
    v_and_b32_e64 v242, 15, v0
    v_lshl_add_u32 v3, v242, 2, v4
    v_and_b32_e64 v243, 7, v0
    v_mul_u32_u24 v243, 2560, v243
    v_add3_u32 v4, v4, v243, 64
    s_lshl_b32 s31, s28, 16
    s_lshl_b32 s33, s6, 13
    s_add_u32 s33, s33, 0x780000
    v_and_b32 v243, 7, v241
    v_lshrrev_b32 v241, 3, v241
    v_mul_u32_u24 v5, 144, v243
    v_lshl_add_u32 v5, v241, 5, v5
    v_bfe_u32 v241, v242, 1, 1
    v_lshl_add_u32 v5, v241, 4, v5
    v_and_b32 v241, 12, v242
    v_add_u32 v5, v241, v5
    v_and_b32_e64 v241, 1, v242
    v_lshl_add_u32 v5, v241, 1, v5
    v_add_u32 v5, 0x5800, v5
    v_and_b32_e64 v243, 7, v0
    v_mul_u32_u24 v6, 144, v243
    v_lshl_add_u32 v6, v240, 5, v6
    v_bfe_u32 v241, v0, 3, 1
    v_lshl_add_u32 v6, v241, 4, v6
    v_add_u32 v6, 0x5800, v6
    v_mul_u32_u24 v241, 0xaaaa, v241
    v_add_u32 v183, 0x4444, v241
    v_mov_b32 v7, 0
    v_lshlrev_b32 v13, 2, v243
    v_add_u32 v13, 0xad00, v13
    v_pk_mov_b32 v[176:177], 0, 0
    v_mov_b32 v178, 0xdddddddd
    s_mov_b32 s39, s6
    s_cmp_eq_u32 s39, 1
    s_cselect_b64 s[36:37], s[64:65], s[62:63]
    s_cmp_eq_u32 s39, 2
    s_cselect_b64 s[36:37], s[66:67], s[36:37]
    s_mov_b32 s12, s36
    s_mov_b32 s13, s37
    s_mov_b32 s14, 0x1c0000
    s_mov_b32 s15, 0x00020000
    s_and_b32 s3, s2, 7
    s_lshr_b32 s4, s2, 3
    s_mul_i32 s5, s4, 57344
    s_mul_i32 s36, s3, 448
    s_and_b32 s36, s36, 0xffffff80
    s_add_u32 s5, s5, s36
    s_lshl_b32 s36, s3, 7
    s_mul_i32 s37, s4, 57344
    s_add_u32 s36, s36, s37
    v_lshrrev_b32_e64 v11, 2, v0
    v_mul_u32_u24 v11, 3584, v11
    v_and_b32_e64 v12, 3, v0
    v_lshl_add_u32 v11, v12, 7, v11
    v_min_u32_e64 v12, 55, v0
    v_lshlrev_b32 v12, 10, v12
    s_cmp_eq_u32 s39, 2
    s_cselect_b32 s38, s36, s5
    s_cselect_b64 vcc, -1, 0
    v_cndmask_b32 v181, v11, v12, vcc
    s_lshl_b32 s39, s6, 0
    s_add_u32 s39, s39, 1
    s_cmp_gt_u32 s6, 2
    s_cselect_b32 s39, 99, s39
    s_and_b32 s3, s2, 7
    s_lshr_b32 s4, s2, 3
    s_and_b32 s5, s6, 1
    s_cmp_eq_u32 s5, 0
    s_cselect_b64 s[36:37], s[62:63], s[64:65]
    s_cmp_lt_u32 s2, 112
    s_cselect_b64 s[36:37], s[36:37], s[66:67]
    s_mov_b32 s68, s36
    s_mov_b32 s69, s37
    s_mov_b32 s70, 0x1c0000
    s_mov_b32 s71, 0x00020000
    s_mul_i32 s76, s3, 14
    s_add_u32 s76, s76, s4
    s_lshl_b32 s77, s3, 2
    s_add_u32 s77, s77, s4
    s_sub_u32 s77, s77, 14
    s_lshr_b32 s5, s6, 1
    s_mul_i32 s5, s5, 458752
    s_lshl_b32 s36, s76, 5
    s_add_u32 s5, s5, s36
    s_mul_i32 s36, s6, 229376
    s_lshl_b32 s37, s77, 5
    s_add_u32 s36, s36, s37
    s_cmp_lt_u32 s2, 112
    s_cselect_b32 s72, s5, s36
    s_movk_i32 s73, 1024
    s_cselect_b32 s73, 3584, s73
    s_cselect_b32 s75, 4, 7
    s_cmp_lt_u32 s2, 144
    s_cselect_b32 s75, s75, 0
    s_mul_i32 s74, s6, 7168
    s_add_u32 s74, s74, 0xe000
    v_lshrrev_b32_e64 v180, 1, v0
    v_mul_lo_u32 v180, v180, s73
    v_and_b32_e64 v12, 1, v0
    v_lshl_add_u32 v180, v12, 4, v180
    s_lshl_b32 s73, s73, 5
    s_mov_b32 s78, s74
    s_lshl_b32 s3, s6, 2
    s_add_u32 s3, s3, 0xad00
    v_mov_b32 v9, s3
    s_movk_i32 s59, 0x6800
    s_lshl_b32 s3, s30, 2
    s_or_b32 s3, s3, s6
    s_cmp_lt_u32 s3, 4
    s_cbranch_scc1 K1_comp
K12_join:
    s_nop 0
    v_pk_mov_b32 v[188:189], 0, 0
    v_pk_mov_b32 v[190:191], 0, 0
    v_pk_mov_b32 v[192:193], 0, 0
    v_pk_mov_b32 v[194:195], 0, 0
    v_pk_mov_b32 v[196:197], 0, 0
    v_pk_mov_b32 v[198:199], 0, 0
    v_pk_mov_b32 v[200:201], 0, 0
    v_pk_mov_b32 v[202:203], 0, 0
    s_min_u32 s3, s75, 4
    s_bfm_b32 s43, s3, 4
    s_sub_u32 s3, s75, s3
    s_bfm_b32 s42, s3, 5
    s_cmp_lt_u32 s6, 4
    s_cbranch_scc1 K2_nb2
    s_cmp_lg_u32 s30, 0
    s_cbranch_scc1 K2_nb2
    s_waitcnt vmcnt(0)
    s_barrier
K2_nb2:
    ds_write2_b32 v9, v176, v176 offset0:0 offset1:8
    s_cmp_lg_u32 s30, 0
    s_cbranch_scc1 K2_safe
    s_cmp_ge_u32 s6, 4
    s_cbranch_scc1 K2_poller
    s_waitcnt lgkmcnt(0)
    s_barrier
    buffer_load_dwordx4 v[16:19], v8, s[8:11], s50 offen sc1
    buffer_load_dwordx4 v[20:23], v8, s[8:11], s51 offen sc1
    buffer_load_dwordx4 v[48:51], v10, s[8:11], s50 offen offset:1024 sc1
    buffer_load_dwordx4 v[52:55], v10, s[8:11], s50 offen offset:1568 sc1
    buffer_load_dwordx4 v[24:27], v8, s[8:11], s52 offen sc1
    buffer_load_dwordx4 v[56:59], v10, s[8:11], s51 offen offset:1024 sc1
    buffer_load_dwordx4 v[60:63], v10, s[8:11], s51 offen offset:1568 sc1
    v_mov_b32 v11, s58
    s_lshl_b32 s3, s2, 6
    s_lshl_b32 s4, s6, 2
    s_add_u32 s3, s3, s4
    s_add_u32 s3, s3, 0x220000
    s_waitcnt vmcnt(7)
    s_mov_b64 exec, 1
    buffer_store_dword v11, v176, s[8:11], s3 offen sc1
    s_mov_b64 exec, -1
    s_branch K2_go
K2_poller:
    v_lshlrev_b32_e64 v12, 4, v0
    s_and_b32 s3, s2, 7
    s_lshl_b32 s3, s3, 14
    s_add_u32 s3, s3, 0x200000
    s_add_u32 s4, s3, 1024
    s_add_u32 s5, s3, 2048
    s_add_u32 s34, s3, 3072
    s_mov_b32 s36, 0
    buffer_load_dword v112, v12, s[8:11], s3 offen sc1
    buffer_load_dword v113, v12, s[8:11], s4 offen sc1
    buffer_load_dword v114, v12, s[8:11], s5 offen sc1
    buffer_load_dword v115, v12, s[8:11], s34 offen sc1
    s_sleep 3
K2_fl:
    buffer_load_dword v120, v12, s[8:11], s3 offen sc1
    buffer_load_dword v121, v12, s[8:11], s4 offen sc1
    buffer_load_dword v122, v12, s[8:11], s5 offen sc1
    buffer_load_dword v123, v12, s[8:11], s34 offen sc1
    s_waitcnt vmcnt(4)
    v_xor_b32 v112, s58, v112
    v_xor_b32 v113, s58, v113
    v_xor_b32 v114, s58, v114
    v_xor_b32_e64 v115, s58, v115
    v_or3_b32 v112, v112, v113, v114
    v_or_b32_e64 v112, v112, v115
    v_cmp_ne_u32 vcc, 0, v112
    s_cbranch_vccz K2_sync0
    buffer_load_dword v112, v12, s[8:11], s3 offen sc1
    buffer_load_dword v113, v12, s[8:11], s4 offen sc1
    buffer_load_dword v114, v12, s[8:11], s5 offen sc1
    buffer_load_dword v115, v12, s[8:11], s34 offen sc1
    s_waitcnt vmcnt(4)
    v_xor_b32 v120, s58, v120
    v_xor_b32 v121, s58, v121
    v_xor_b32 v122, s58, v122
    v_xor_b32_e64 v123, s58, v123
    v_or3_b32 v120, v120, v121, v122
    v_or_b32 v120, v120, v123
    v_cmp_ne_u32 vcc, 0, v120
    s_cbranch_vccz K2_sync0
    s_add_u32 s36, s36, 1
    s_cmp_lt_u32 s36, 0x40000
    s_cbranch_scc1 K2_fl
K2_sync0:
    s_lshl_b32 s3, s2, 3
    s_or_b32 s3, s3, s6
    s_cmp_lg_u32 s3, 4
    s_cbranch_scc1 K2_sync1
    v_mov_b32 v11, s58
    s_mov_b32 s3, 0x227000
    s_mov_b64 exec, 1
    buffer_store_dword v11, v176, s[8:11], s3 offen sc1
    s_mov_b64 exec, -1
K2_sync1:
    s_mov_b32 s36, 0
K2_pre:
    s_nop 0
    buffer_load_dwordx4 v[16:19], v8, s[8:11], s50 offen sc1
    buffer_load_dwordx4 v[20:23], v8, s[8:11], s51 offen sc1
    buffer_load_dwordx4 v[48:51], v10, s[8:11], s50 offen offset:1024 sc1
    buffer_load_dwordx4 v[52:55], v10, s[8:11], s50 offen offset:1568 sc1
    buffer_load_dwordx4 v[24:27], v8, s[8:11], s52 offen sc1
    buffer_load_dwordx4 v[56:59], v10, s[8:11], s51 offen offset:1024 sc1
    buffer_load_dwordx4 v[60:63], v10, s[8:11], s51 offen offset:1568 sc1
    s_add_u32 s36, s36, 1
    s_waitcnt vmcnt(0)
    v_max3_u32 v182, v16, v20, v24
    v_max3_u32 v182, v182, v48, v52
    v_max3_u32 v182, v182, v56, v60
    v_cmp_eq_u32 vcc, -1, v182
    s_cbranch_vccz K2_pok
    s_cmp_lt_u32 s36, 0x40000
    s_cbranch_scc1 K2_pre
K2_pok:
    v_mov_b32 v11, s58
    s_lshl_b32 s3, s2, 6
    s_lshl_b32 s4, s6, 2
    s_add_u32 s3, s3, s4
    s_add_u32 s3, s3, 0x220000
    s_waitcnt vmcnt(7)
    s_mov_b64 exec, 1
    buffer_store_dword v11, v176, s[8:11], s3 offen sc1
    s_mov_b64 exec, -1
    s_waitcnt lgkmcnt(0)
    s_barrier
    s_cmp_lg_u32 s6, 4
    s_cbranch_scc1 K2_go
    ds_read_b128 v[184:187], v1
    s_waitcnt vmcnt(6)
    v_max_u32 v182, v16, v20
    v_cmp_eq_u32 vcc, -1, v182
    s_cbranch_vccnz K2_rtm
K2_rbm:
    s_waitcnt lgkmcnt(0)
    v_mfma_f32_32x32x16_bf16 v[112:127], v[16:19], v[184:187], 0
    v_mfma_f32_32x32x16_bf16 v[128:143], v[20:23], v[184:187], 0
    s_nop 10
    v_max3_f32 v11, v112, v113, v114
    v_max3_f32 v11, v11, v115, v116
    v_max3_f32 v11, v11, v117, v118
    v_max3_f32 v11, v11, v119, v120
    v_max3_f32 v11, v11, v121, v122
    v_max3_f32 v11, v11, v123, v124
    v_max3_f32 v11, v11, v125, v126
    v_max3_f32 v11, v11, v127, v128
    v_max3_f32 v11, v11, v129, v130
    v_max3_f32 v11, v11, v131, v132
    v_max3_f32 v11, v11, v133, v134
    v_max3_f32 v11, v11, v135, v136
    v_max3_f32 v11, v11, v137, v138
    v_max3_f32 v11, v11, v139, v140
    v_max3_f32 v11, v11, v141, v142
    v_max_f32 v11, v11, v143
    v_mov_b32 v12, v11
    s_nop 1
    v_permlane32_swap_b32 v12, v11
    v_max_f32_e64 v11, v11, v12
    v_sub_f32 v112, 0xc2c00000, v11
    v_sub_f32 v113, 0xc2c00000, v11
    v_sub_f32 v114, 0xc2c00000, v11
    v_sub_f32 v115, 0xc2c00000, v11
    ds_write_b128 v15, v[112:115] offset:9216
    s_branch K2_go
K2_safe:
    v_and_b32 v11, 31, v0
    v_lshlrev_b32_e64 v244, 2, v11
    v_add_u32 v244, 0xb000, v244
    s_lshl_b32 s3, s44, 7
    v_add_u32 v245, s3, v244
    v_mov_b32 v11, 0xff800000
    ds_write_b32 v245, v11
    s_waitcnt vmcnt(0) lgkmcnt(0)
    s_barrier
    v_mov_b32 v12, v1
    s_mov_b32 s29, 0
K2_safe_loop:
    ds_read_b128 v[236:239], v12
    v_mov_b32 v11, 0xff800000
    s_waitcnt lgkmcnt(0)
    v_mfma_f32_32x32x16_bf16 v[112:127], v[16:19], v[236:239], 0
    s_nop 11
    v_max3_f32 v11, v11, v112, v113
    v_max3_f32 v11, v11, v114, v115
    v_max3_f32 v11, v11, v116, v117
    v_max3_f32 v11, v11, v118, v119
    v_max3_f32 v11, v11, v120, v121
    v_max3_f32 v11, v11, v122, v123
    v_max3_f32 v11, v11, v124, v125
    v_max3_f32 v11, v11, v126, v127
    v_mfma_f32_32x32x16_bf16 v[112:127], v[20:23], v[236:239], 0
    s_nop 11
    s_nop 0
    v_max3_f32 v11, v11, v112, v113
    v_max3_f32 v11, v11, v114, v115
    v_max3_f32 v11, v11, v116, v117
    v_max3_f32 v11, v11, v118, v119
    v_max3_f32 v11, v11, v120, v121
    v_max3_f32 v11, v11, v122, v123
    v_max3_f32 v11, v11, v124, v125
    v_max3_f32 v11, v11, v126, v127
    v_mfma_f32_32x32x16_bf16 v[112:127], v[24:27], v[236:239], 0
    s_nop 11
    s_nop 0
    v_max3_f32 v11, v11, v112, v113
    v_max3_f32 v11, v11, v114, v115
    v_max3_f32 v11, v11, v116, v117
    v_max3_f32 v11, v11, v118, v119
    v_max3_f32 v11, v11, v120, v121
    v_max3_f32 v11, v11, v122, v123
    v_max3_f32 v11, v11, v124, v125
    v_max3_f32 v11, v11, v126, v127
    v_mfma_f32_32x32x16_bf16 v[112:127], v[28:31], v[236:239], 0
    s_nop 11
    s_nop 0
    v_max3_f32 v11, v11, v112, v113
    v_max3_f32 v11, v11, v114, v115
    v_max3_f32 v11, v11, v116, v117
    v_max3_f32 v11, v11, v118, v119
    v_max3_f32 v11, v11, v120, v121
    v_max3_f32 v11, v11, v122, v123
    v_max3_f32 v11, v11, v124, v125
    v_max3_f32 v11, v11, v126, v127
    v_mfma_f32_32x32x16_bf16 v[112:127], v[32:35], v[236:239], 0
    s_nop 11
    s_nop 0
    v_max3_f32 v11, v11, v112, v113
    v_max3_f32 v11, v11, v114, v115
    v_max3_f32 v11, v11, v116, v117
    v_max3_f32 v11, v11, v118, v119
    v_max3_f32 v11, v11, v120, v121
    v_max3_f32 v11, v11, v122, v123
    v_max3_f32 v11, v11, v124, v125
    v_max3_f32 v11, v11, v126, v127
    v_mfma_f32_32x32x16_bf16 v[112:127], v[36:39], v[236:239], 0
    s_nop 11
    s_nop 0
    v_max3_f32 v11, v11, v112, v113
    v_max3_f32 v11, v11, v114, v115
    v_max3_f32 v11, v11, v116, v117
    v_max3_f32 v11, v11, v118, v119
    v_max3_f32 v11, v11, v120, v121
    v_max3_f32 v11, v11, v122, v123
    v_max3_f32 v11, v11, v124, v125
    v_max3_f32 v11, v11, v126, v127
    v_mfma_f32_32x32x16_bf16 v[112:127], v[40:43], v[236:239], 0
    s_nop 11
    s_nop 0
    v_max3_f32 v11, v11, v112, v113
    v_max3_f32 v11, v11, v114, v115
    v_max3_f32 v11, v11, v116, v117
    v_max3_f32 v11, v11, v118, v119
    v_max3_f32 v11, v11, v120, v121
    v_max3_f32 v11, v11, v122, v123
    v_max3_f32 v11, v11, v124, v125
    v_max3_f32 v11, v11, v126, v127
    v_mfma_f32_32x32x16_bf16 v[112:127], v[44:47], v[236:239], 0
    s_nop 11
    s_nop 0
    v_max3_f32 v11, v11, v112, v113
    v_max3_f32 v11, v11, v114, v115
    v_max3_f32 v11, v11, v116, v117
    v_max3_f32 v11, v11, v118, v119
    v_max3_f32 v11, v11, v120, v121
    v_max3_f32 v11, v11, v122, v123
    v_max3_f32 v11, v11, v124, v125
    v_max3_f32 v11, v11, v126, v127
    ds_max_f32 v244, v11
    v_add_u32 v12, 1024, v12
    v_add_u32 v244, 128, v244
    s_add_u32 s29, s29, 1
    s_cmp_lt_u32 s29, 8
    s_cbranch_scc1 K2_safe_loop
    s_waitcnt lgkmcnt(0)
    s_barrier
    ds_read_b32 v11, v245
    s_waitcnt lgkmcnt(0)
    v_sub_f32 v236, 0, v11
    v_sub_f32 v237, 0, v11
    v_sub_f32 v238, 0, v11
    v_sub_f32 v239, 0, v11
    ds_write_b128 v15, v[236:239] offset:9216
K2_go:
    s_waitcnt lgkmcnt(0)
    s_barrier
    ds_read_b128 v[184:187], v1
    ds_read_b128 v[160:163], v1 offset:9216
    ds_read_b128 v[164:167], v1 offset:9216
    ds_read_b128 v[168:171], v1 offset:9216
    ds_read_b128 v[172:175], v1 offset:9216
    v_add_u32 v1, 1024, v1
    s_waitcnt vmcnt(7)
    v_cmp_eq_u32 vcc, -1, v16
    s_cbranch_vccnz K2_rts
K2_rbs:
    s_waitcnt lgkmcnt(0)
    v_mfma_f32_32x32x16_bf16 v[112:127], v[16:19], v[184:187], v[160:175]
    s_mov_b32 s29, 1
    s_setprio 3
    buffer_load_dwordx4 v[28:31], v8, s[8:11], s53 offen sc1
    buffer_load_dwordx4 v[64:67], v10, s[8:11], s52 offen offset:1024 sc1
    buffer_load_dwordx4 v[68:71], v10, s[8:11], s52 offen offset:1568 sc1
    s_nop 6
    v_exp_f32 v112, v112
    v_exp_f32 v113, v113
    v_exp_f32 v114, v114
    v_exp_f32 v115, v115
    v_exp_f32 v116, v116
    s_waitcnt vmcnt(9)
    s_waitcnt vmcnt(7)
    v_max3_u32 v182, v20, v48, v52
    v_cmp_eq_u32 vcc, -1, v182
    s_cbranch_vccnz K2_rt0
K2_rb0:
    v_mfma_f32_32x32x16_bf16 v[128:143], v[20:23], v[184:187], v[160:175]
    buffer_load_dwordx4 v[32:35], v8, s[8:11], s54 offen sc1
    v_exp_f32 v117, v117
    v_exp_f32 v118, v118
    v_exp_f32 v119, v119
    v_exp_f32 v120, v120
    v_exp_f32 v121, v121
    v_exp_f32 v122, v122
    v_exp_f32_e64 v123, v123
    buffer_load_dwordx4 v[72:75], v10, s[8:11], s53 offen offset:1024 sc1
    v_mfma_f32_32x32x8bf16_1k v[144:159], v[176:177], v[176:177], 0
    v_exp_f32 v124, v124
    v_exp_f32 v125, v125
    v_exp_f32 v126, v126
    v_exp_f32 v127, v127
    v_smfmac_f32_32x32x32_bf16 v[144:159], v[48:51], v[112:119], v178
    buffer_load_dwordx4 v[76:79], v10, s[8:11], s53 offen offset:1568 sc1
    v_exp_f32 v128, v128
    v_exp_f32 v129, v129
    v_smfmac_f32_32x32x32_bf16 v[144:159], v[52:55], v[120:127], v178
    v_exp_f32 v130, v130
    v_exp_f32 v131, v131
    v_exp_f32_e64 v132, v132
    s_waitcnt vmcnt(9)
    s_waitcnt vmcnt(7)
    v_max3_u32 v182, v24, v56, v60
    v_cmp_eq_u32 vcc, -1, v182
    s_cbranch_vccnz K2_rt1
K2_rb1:
    v_mfma_f32_32x32x16_bf16 v[112:127], v[24:27], v[184:187], v[160:175]
    buffer_load_dwordx4 v[36:39], v8, s[8:11], s55 offen sc1
    v_exp_f32 v133, v133
    v_exp_f32 v134, v134
    v_exp_f32_e64 v135, v135
    buffer_load_dword v11, v176, s[8:11], s45 offen sc1
    v_exp_f32 v136, v136
    v_exp_f32 v137, v137
    v_smfmac_f32_32x32x32_bf16 v[144:159], v[56:59], v[128:135], v178
    buffer_load_dwordx4 v[80:83], v10, s[8:11], s54 offen offset:1024 sc1
    v_exp_f32 v138, v138
    v_exp_f32 v139, v139
    v_exp_f32 v140, v140
    v_exp_f32 v141, v141
    v_exp_f32_e64 v142, v142
    buffer_load_dwordx4 v[84:87], v10, s[8:11], s54 offen offset:1568 sc1
    v_exp_f32 v143, v143
    v_exp_f32 v112, v112
    v_exp_f32_e64 v113, v113
    v_smfmac_f32_32x32x32_bf16 v[144:159], v[60:63], v[136:143], v178
    v_exp_f32 v114, v114
    v_exp_f32 v115, v115
    v_exp_f32_e64 v116, v116
    s_waitcnt vmcnt(9)
    s_waitcnt vmcnt(7)
    v_max3_u32 v182, v28, v64, v68
    v_cmp_eq_u32 vcc, -1, v182
    s_cbranch_vccnz K2_rt2
K2_rb2:
    v_mfma_f32_32x32x16_bf16 v[128:143], v[28:31], v[184:187], v[160:175]
    buffer_load_dwordx4 v[40:43], v8, s[8:11], s56 offen sc1
    v_exp_f32 v117, v117
    v_exp_f32 v118, v118
    v_exp_f32 v119, v119
    s_waitcnt vmcnt(3)
    v_cmp_ne_u32 vcc, s58, v11
    s_cbranch_vccnz K2_qspin
K2_qback:
    buffer_load_dwordx4 v[236:239], v8, s[8:11], s32 offen sc1
    v_exp_f32 v120, v120
    v_exp_f32 v121, v121
    v_smfmac_f32_32x32x32_bf16 v[144:159], v[64:67], v[112:119], v178
    buffer_load_dwordx4 v[88:91], v10, s[8:11], s55 offen offset:1024 sc1
    v_exp_f32 v122, v122
    v_exp_f32 v123, v123
    v_exp_f32 v124, v124
    v_exp_f32 v125, v125
    v_exp_f32_e64 v126, v126
    buffer_load_dwordx4 v[92:95], v10, s[8:11], s55 offen offset:1568 sc1
    v_exp_f32 v127, v127
    s_setprio 2
    v_exp_f32 v128, v128
    v_exp_f32 v129, v129
    v_smfmac_f32_32x32x32_bf16 v[144:159], v[68:71], v[120:127], v178
    v_exp_f32 v130, v130
    v_exp_f32 v131, v131
    v_exp_f32_e64 v132, v132
    v_max3_u32 v182, v32, v72, v76
    v_cmp_eq_u32 vcc, -1, v182
    s_cbranch_vccnz K2_rt3
K2_rb3:
    v_mfma_f32_32x32x16_bf16 v[112:127], v[32:35], v[184:187], v[160:175]
    buffer_load_dwordx4 v[44:47], v8, s[8:11], s57 offen sc1
    v_exp_f32 v133, v133
    v_exp_f32 v134, v134
    v_exp_f32 v135, v135
    v_exp_f32 v136, v136
    v_exp_f32_e64 v137, v137
    v_smfmac_f32_32x32x32_bf16 v[144:159], v[72:75], v[128:135], v178
    buffer_load_dwordx4 v[96:99], v10, s[8:11], s56 offen offset:1024 sc1
    v_exp_f32 v138, v138
    v_exp_f32 v139, v139
    v_exp_f32 v140, v140
    v_exp_f32 v141, v141
    v_exp_f32_e64 v142, v142
    buffer_load_dwordx4 v[100:103], v10, s[8:11], s56 offen offset:1568 sc1
    v_exp_f32 v143, v143
    v_exp_f32 v112, v112
    v_exp_f32_e64 v113, v113
    v_smfmac_f32_32x32x32_bf16 v[144:159], v[76:79], v[136:143], v178
    v_exp_f32 v114, v114
    v_exp_f32 v115, v115
    v_exp_f32 v116, v116
    s_waitcnt vmcnt(7)
    v_max3_u32 v182, v36, v80, v84
    v_cmp_eq_u32 vcc, -1, v182
    s_cbranch_vccnz K2_rt4
K2_rb4:
    v_mfma_f32_32x32x16_bf16 v[128:143], v[36:39], v[184:187], v[160:175]
    v_exp_f32 v117, v117
    v_exp_f32 v118, v118
    v_exp_f32 v119, v119
    v_exp_f32 v120, v120
    v_exp_f32_e64 v121, v121
    v_smfmac_f32_32x32x32_bf16 v[144:159], v[80:83], v[112:119], v178
    buffer_load_dwordx4 v[104:107], v10, s[8:11], s57 offen offset:1024 sc1
    v_exp_f32 v122, v122
    v_exp_f32 v123, v123
    v_exp_f32 v124, v124
    s_waitcnt vmcnt(6)
    ds_write_b128 v15, v[236:239]
    v_mfma_f32_32x32x16_bf16 v[204:219], v[16:19], v[236:239], 0
    v_mfma_f32_32x32x16_bf16 v[220:235], v[20:23], v[236:239], 0
    v_exp_f32 v125, v125
    v_exp_f32 v126, v126
    buffer_load_dwordx4 v[108:111], v10, s[8:11], s57 offen offset:1568 sc1
    v_exp_f32 v127, v127
    s_setprio 1
    v_exp_f32 v128, v128
    v_exp_f32 v129, v129
    v_smfmac_f32_32x32x32_bf16 v[144:159], v[84:87], v[120:127], v178
    v_exp_f32 v130, v130
    v_exp_f32 v131, v131
    v_exp_f32 v132, v132
    s_waitcnt vmcnt(5)
    v_max3_u32 v182, v40, v88, v92
    v_cmp_eq_u32 vcc, -1, v182
    s_cbranch_vccnz K2_rt5
K2_rb5:
    v_mfma_f32_32x32x16_bf16 v[112:127], v[40:43], v[184:187], v[160:175]
    v_exp_f32 v133, v133
    v_exp_f32 v134, v134
    v_exp_f32_e64 v135, v135
    s_cmp_lg_u32 s30, 0
    s_cbranch_scc1 K2_keepm
    v_max3_f32 v11, v204, v205, v206
    v_max3_f32 v11, v11, v207, v208
    v_max3_f32 v11, v11, v209, v210
    v_max3_f32 v11, v11, v211, v212
    v_max3_f32 v11, v11, v213, v214
    v_max3_f32 v11, v11, v215, v216
    v_max3_f32 v11, v11, v217, v218
    v_max3_f32 v11, v11, v219, v220
    v_max3_f32 v11, v11, v221, v222
    v_max3_f32 v11, v11, v223, v224
    v_max3_f32 v11, v11, v225, v226
    v_max3_f32 v11, v11, v227, v228
    v_max3_f32 v11, v11, v229, v230
    v_max3_f32 v11, v11, v231, v232
    v_max3_f32 v11, v11, v233, v234
    v_max_f32 v11, v11, v235
    v_mov_b32 v12, v11
    s_nop 1
    v_permlane32_swap_b32 v12, v11
    v_max_f32_e64 v11, v11, v12
    v_sub_f32 v204, 0xc2c00000, v11
    v_sub_f32 v205, 0xc2c00000, v11
    v_sub_f32 v206, 0xc2c00000, v11
    v_sub_f32 v207, 0xc2c00000, v11
    ds_write_b128 v15, v[204:207] offset:9216
K2_keepm:
    v_exp_f32 v136, v136
    v_exp_f32 v137, v137
    v_smfmac_f32_32x32x32_bf16 v[144:159], v[88:91], v[128:135], v178
    v_exp_f32 v138, v138
    v_exp_f32 v139, v139
    v_exp_f32 v140, v140
    s_add_u32 s34, s33, s31
    s_add_u32 s35, s34, 4096
    s_add_u32 s31, s31, 0x10000
    s_and_b32 s31, s31, 0x7ffff
    buffer_load_dwordx4 v[204:207], v8, s[8:11], s34 offen offset:0 sc1
    v_exp_f32 v141, v141
    v_exp_f32 v142, v142
    buffer_load_dwordx4 v[208:211], v8, s[8:11], s35 offen offset:0 sc1
    v_exp_f32 v143, v143
    v_exp_f32 v112, v112
    v_exp_f32_e64 v113, v113
    v_smfmac_f32_32x32x32_bf16 v[144:159], v[92:95], v[136:143], v178
    v_exp_f32 v114, v114
    v_exp_f32 v115, v115
    v_exp_f32_e64 v116, v116
    s_waitcnt vmcnt(6)
    s_waitcnt vmcnt(4)
    v_max3_u32 v182, v44, v96, v100
    v_cmp_eq_u32 vcc, -1, v182
    s_cbranch_vccnz K2_rt6
K2_rb6:
    v_mfma_f32_32x32x16_bf16 v[128:143], v[44:47], v[184:187], v[160:175]
    v_exp_f32 v117, v117
    v_exp_f32 v118, v118
    v_exp_f32_e64 v119, v119
    buffer_load_dwordx4 v[212:215], v8, s[8:11], s34 offen offset:1024 sc1
    v_exp_f32 v120, v120
    v_exp_f32 v121, v121
    s_waitcnt lgkmcnt(0)
    s_barrier
    ds_read_b128 v[184:187], v1
    ds_read_b128 v[160:163], v1 offset:9216
    ds_read_b128 v[164:167], v1 offset:9216
    ds_read_b128 v[168:171], v1 offset:9216
    ds_read_b128 v[172:175], v1 offset:9216
    v_add_u32 v1, 1024, v1
    v_smfmac_f32_32x32x32_bf16 v[144:159], v[96:99], v[112:119], v178
    v_exp_f32 v122, v122
    v_exp_f32 v123, v123
    v_exp_f32_e64 v124, v124
    buffer_load_dwordx4 v[216:219], v8, s[8:11], s35 offen offset:1024 sc1
    v_exp_f32 v125, v125
    v_exp_f32 v126, v126
    buffer_load_dwordx4 v[220:223], v8, s[8:11], s34 offen offset:2048 sc1
    v_exp_f32 v127, v127
    v_exp_f32 v128, v128
    v_exp_f32_e64 v129, v129
    v_smfmac_f32_32x32x32_bf16 v[144:159], v[100:103], v[120:127], v178
    v_exp_f32 v130, v130
    v_exp_f32 v131, v131
    v_exp_f32 v132, v132
    s_waitcnt lgkmcnt(0)
    s_waitcnt vmcnt(5)
    v_max_u32 v182, v104, v108
    v_cmp_eq_u32 vcc, -1, v182
    s_cbranch_vccnz K2_rt7
K2_rb7:
    v_mfma_f32_32x32x16_bf16 v[112:127], v[16:19], v[184:187], v[160:175]
    v_exp_f32 v133, v133
    v_exp_f32 v134, v134
    v_exp_f32_e64 v135, v135
    buffer_load_dwordx4 v[224:227], v8, s[8:11], s35 offen offset:2048 sc1
    v_exp_f32 v136, v136
    v_exp_f32 v137, v137
    v_smfmac_f32_32x32x32_bf16 v[144:159], v[104:107], v[128:135], v178
    v_exp_f32 v138, v138
    v_exp_f32 v139, v139
    v_exp_f32_e64 v140, v140
    buffer_load_dwordx4 v[228:231], v8, s[8:11], s34 offen offset:3072 sc1
    v_exp_f32 v141, v141
    v_exp_f32 v142, v142
    buffer_load_dwordx4 v[232:235], v8, s[8:11], s35 offen offset:3072 sc1
    v_mov_b32 v248, -1
    v_mov_b32 v249, -1
    v_lshrrev_b32_e64 v250, 1, v8
    s_add_u32 s3, s7, s6
    s_lshl_b32 s3, s3, 9
    s_add_u32 s3, s3, 0x300000
    buffer_store_dwordx2 v[248:249], v250, s[8:11], s3 offen sc1
    v_exp_f32 v143, v143
.p2align 3
K2_round:
    s_setprio 1
    v_exp_f32 v112, v112
    v_exp_f32_e64 v113, v113
    v_smfmac_f32_32x32x32_bf16 v[144:159], v[108:111], v[136:143], v178
    v_exp_f32 v114, v114
    v_exp_f32 v115, v115
    v_exp_f32_e64 v116, v116
    v_mfma_f32_32x32x16_bf16 v[128:143], v[20:23], v[184:187], v[160:175]
    v_exp_f32 v117, v117
    v_exp_f32 v118, v118
    v_exp_f32 v119, v119
    v_exp_f32 v120, v120
    v_exp_f32 v121, v121
    v_exp_f32 v122, v122
    v_exp_f32 v123, v123
    s_nop 0
    ds_write_b128 v2, v[144:147]
    ds_write_b128 v2, v[148:151] offset:32
    ds_write_b32 v179, v152 offset:64
    ds_write_b32 v9, v1
    v_mfma_f32_32x32x8bf16_1k v[144:159], v[176:177], v[176:177], 0
    v_exp_f32 v124, v124
    v_exp_f32 v125, v125
    v_exp_f32 v126, v126
    v_exp_f32 v127, v127
    v_smfmac_f32_32x32x32_bf16 v[144:159], v[48:51], v[112:119], v178
    s_setprio 0
    v_exp_f32 v128, v128
    v_exp_f32_e64 v129, v129
    v_smfmac_f32_32x32x32_bf16 v[144:159], v[52:55], v[120:127], v178
    v_exp_f32 v130, v130
    v_exp_f32 v131, v131
    v_exp_f32_e64 v132, v132
    v_mfma_f32_32x32x16_bf16 v[112:127], v[24:27], v[184:187], v[160:175]
    v_exp_f32 v133, v133
    v_exp_f32 v134, v134
    v_exp_f32 v135, v135
    v_exp_f32 v136, v136
    v_exp_f32_e64 v137, v137
    v_smfmac_f32_32x32x32_bf16 v[144:159], v[56:59], v[128:135], v178
    v_exp_f32 v138, v138
    v_exp_f32 v139, v139
    v_exp_f32 v140, v140
    v_exp_f32 v141, v141
    v_exp_f32 v142, v142
    v_exp_f32 v143, v143
    s_setprio 2
    v_exp_f32 v112, v112
    v_exp_f32_e64 v113, v113
    v_smfmac_f32_32x32x32_bf16 v[144:159], v[60:63], v[136:143], v178
    v_exp_f32 v114, v114
    v_exp_f32 v115, v115
    v_exp_f32_e64 v116, v116
    v_mfma_f32_32x32x16_bf16 v[128:143], v[28:31], v[184:187], v[160:175]
    ds_read_b32 v14, v13 offset:0
    v_exp_f32 v117, v117
    v_exp_f32 v118, v118
    v_exp_f32 v119, v119
    s_bitcmp1_b32 s43, s29
    s_cbranch_scc1 K2_stg
K2_stgb:
    v_exp_f32 v120, v120
    v_exp_f32_e64 v121, v121
    v_smfmac_f32_32x32x32_bf16 v[144:159], v[64:67], v[112:119], v178
    s_waitcnt lgkmcnt(0)
    v_cmp_gt_u32 vcc, s59, v14
    s_cbranch_vccnz K2_spin0
K2_back0:
    ds_read_b32 v248, v4
    ds_read2st64_b32 v[240:241], v3 offset0:0 offset1:10
    ds_read2st64_b32 v[242:243], v3 offset0:20 offset1:30
    ds_read2st64_b32 v[244:245], v3 offset0:40 offset1:50
    ds_read2st64_b32 v[246:247], v3 offset0:60 offset1:70
    v_exp_f32 v122, v122
    v_exp_f32 v123, v123
    v_exp_f32 v124, v124
    v_exp_f32 v125, v125
    v_exp_f32 v126, v126
    v_exp_f32 v127, v127
    s_waitcnt lgkmcnt(0)
    v_add_f32_dpp v248, v248, v248 quad_perm:[1,0,3,2] row_mask:0xf bank_mask:0xf
    v_pk_add_f32 v[240:241], v[240:241], v[242:243]
    v_pk_add_f32 v[244:245], v[244:245], v[246:247]
    v_add_f32_dpp v248, v248, v248 quad_perm:[2,3,0,1] row_mask:0xf bank_mask:0xf
    v_pk_add_f32 v[240:241], v[240:241], v[244:245]
    v_add_f32_e64 v240, v240, v241
    v_add_f32_dpp v248, v248, v248 row_half_mirror row_mask:0xf bank_mask:0xf
    v_rcp_f32_e64 v241, v248
    v_maximum3_f32 v7, v7, v248, abs(v240)
    v_mul_f32_e64 v240, v240, v241
    v_cvt_pk_bf16_f32 v240, v240, v240
    ds_write_b16 v5, v240
    ds_write_b32 v9, v1 offset:32
    v_exp_f32 v128, v128
    v_exp_f32 v129, v129
    v_smfmac_f32_32x32x32_bf16 v[144:159], v[68:71], v[120:127], v178
    v_exp_f32 v130, v130
    v_exp_f32 v131, v131
    v_exp_f32_e64 v132, v132
    v_mfma_f32_32x32x16_bf16 v[112:127], v[32:35], v[184:187], v[160:175]
    v_exp_f32 v133, v133
    v_exp_f32 v134, v134
    v_exp_f32 v135, v135
    v_exp_f32 v136, v136
    v_exp_f32_e64 v137, v137
    v_smfmac_f32_32x32x32_bf16 v[144:159], v[72:75], v[128:135], v178
    v_exp_f32 v138, v138
    v_exp_f32 v139, v139
    v_exp_f32 v140, v140
    v_exp_f32 v141, v141
    v_exp_f32 v142, v142
    v_exp_f32 v143, v143
    s_setprio 0
    v_exp_f32 v112, v112
    v_exp_f32_e64 v113, v113
    v_smfmac_f32_32x32x32_bf16 v[144:159], v[76:79], v[136:143], v178
    v_exp_f32 v114, v114
    v_exp_f32 v115, v115
    v_exp_f32_e64 v116, v116
    v_mfma_f32_32x32x16_bf16 v[128:143], v[36:39], v[184:187], v[160:175]
    v_exp_f32 v117, v117
    v_exp_f32 v118, v118
    v_exp_f32 v119, v119
    v_exp_f32 v120, v120
    v_exp_f32_e64 v121, v121
    v_smfmac_f32_32x32x32_bf16 v[144:159], v[80:83], v[112:119], v178
    ds_read_b32 v14, v13 offset:32
    v_exp_f32 v122, v122
    v_exp_f32 v123, v123
    v_exp_f32 v124, v124
    v_exp_f32 v125, v125
    v_exp_f32 v126, v126
    v_exp_f32 v127, v127
    s_setprio 3
    v_exp_f32 v128, v128
    v_exp_f32_e64 v129, v129
    v_smfmac_f32_32x32x32_bf16 v[144:159], v[84:87], v[120:127], v178
    v_exp_f32 v130, v130
    v_exp_f32 v131, v131
    v_exp_f32 v132, v132
    s_waitcnt lgkmcnt(0)
    v_cmp_gt_u32 vcc, s59, v14
    s_cbranch_vccnz K2_spin1
K2_back1:
    ds_read_b128 v[236:239], v6
    s_waitcnt vmcnt(0)
    v_mfma_f32_32x32x16_bf16 v[112:127], v[40:43], v[184:187], v[160:175]
    v_exp_f32 v133, v133
    v_exp_f32 v134, v134
    v_exp_f32 v135, v135
    v_exp_f32 v136, v136
    v_exp_f32 v137, v137
    v_smfmac_f32_32x32x32_bf16 v[144:159], v[88:91], v[128:135], v178
    v_exp_f32 v138, v138
    v_exp_f32 v139, v139
    v_exp_f32 v140, v140
    s_waitcnt lgkmcnt(0)
    v_smfmac_f32_16x16x64_bf16 v[188:191], v[236:239], v[204:211], v183
    s_add_u32 s34, s33, s31
    s_add_u32 s35, s34, 4096
    s_add_u32 s31, s31, 0x10000
    s_and_b32 s31, s31, 0x7ffff
    buffer_load_dwordx4 v[204:207], v8, s[8:11], s34 offen offset:0 sc1
    v_exp_f32 v141, v141
    v_exp_f32_e64 v142, v142
    buffer_load_dwordx4 v[208:211], v8, s[8:11], s35 offen offset:0 sc1
    v_exp_f32 v143, v143
    v_exp_f32 v112, v112
    v_exp_f32_e64 v113, v113
    v_smfmac_f32_32x32x32_bf16 v[144:159], v[92:95], v[136:143], v178
    v_exp_f32 v114, v114
    v_exp_f32 v115, v115
    v_exp_f32_e64 v116, v116
    v_mfma_f32_32x32x16_bf16 v[128:143], v[44:47], v[184:187], v[160:175]
    v_exp_f32 v117, v117
    v_exp_f32 v118, v118
    v_exp_f32_e64 v119, v119
    v_smfmac_f32_16x16x64_bf16 v[192:195], v[236:239], v[212:219], v183
    buffer_load_dwordx4 v[212:215], v8, s[8:11], s34 offen offset:1024 sc1
    v_exp_f32 v120, v120
    v_exp_f32 v121, v121
    ds_read_b128 v[184:187], v1
    ds_read_b128 v[160:163], v1 offset:9216
    ds_read_b128 v[164:167], v1 offset:9216
    ds_read_b128 v[168:171], v1 offset:9216
    ds_read_b128 v[172:175], v1 offset:9216
    v_add_u32 v1, 1024, v1
    v_smfmac_f32_32x32x32_bf16 v[144:159], v[96:99], v[112:119], v178
    v_exp_f32 v122, v122
    v_exp_f32 v123, v123
    v_exp_f32_e64 v124, v124
    buffer_load_dwordx4 v[216:219], v8, s[8:11], s35 offen offset:1024 sc1
    v_exp_f32 v125, v125
    v_exp_f32 v126, v126
    v_smfmac_f32_16x16x64_bf16 v[196:199], v[236:239], v[220:227], v183
    buffer_load_dwordx4 v[220:223], v8, s[8:11], s34 offen offset:2048 sc1
    v_exp_f32 v127, v127
    s_setprio 2
    v_exp_f32 v128, v128
    v_exp_f32 v129, v129
    v_smfmac_f32_32x32x32_bf16 v[144:159], v[100:103], v[120:127], v178
    v_exp_f32 v130, v130
    v_exp_f32 v131, v131
    v_exp_f32 v132, v132
    s_waitcnt lgkmcnt(0)
    v_mfma_f32_32x32x16_bf16 v[112:127], v[16:19], v[184:187], v[160:175]
    v_exp_f32 v133, v133
    v_exp_f32 v134, v134
    v_exp_f32_e64 v135, v135
    buffer_load_dwordx4 v[224:227], v8, s[8:11], s35 offen offset:2048 sc1
    v_exp_f32 v136, v136
    v_exp_f32 v137, v137
    v_smfmac_f32_32x32x32_bf16 v[144:159], v[104:107], v[128:135], v178
    v_exp_f32 v138, v138
    v_exp_f32 v139, v139
    v_exp_f32_e64 v140, v140
    v_smfmac_f32_16x16x64_bf16 v[200:203], v[236:239], v[228:235], v183
    buffer_load_dwordx4 v[228:231], v8, s[8:11], s34 offen offset:3072 sc1
    v_exp_f32 v141, v141
    v_exp_f32 v142, v142
    buffer_load_dwordx4 v[232:235], v8, s[8:11], s35 offen offset:3072 sc1
    s_cmp_eq_u32 s29, s39
    s_cbranch_scc1 K2_side
K2_sideb:
    v_exp_f32_e64 v143, v143
    s_addk_i32 s59, 1024
    s_add_u32 s29, s29, 1
    s_cmp_lt_u32 s29, 8
    s_cbranch_scc1 K2_round
    v_smfmac_f32_32x32x32_bf16 v[144:159], v[108:111], v[136:143], v178
    s_add_u32 s3, s7, s6
    s_lshl_b32 s4, s3, 10
    buffer_load_dwordx4 v[160:163], v8, s[16:19], s4 offen
    buffer_load_dwordx4 v[164:167], v8, s[24:27], 0 offen
    s_nop 7
    ds_write_b128 v2, v[144:147]
    ds_write_b128 v2, v[148:151] offset:32
    ds_write_b32 v179, v152 offset:64
    v_bfe_u32 v11, v0, 4, 1
    v_lshrrev_b32 v12, 5, v0
    v_lshl_add_u32 v11, v11, 1, v12
    v_mul_u32_u24 v11, 2080, v11
    v_and_b32_e64 v12, 15, v0
    v_lshl_add_u32 v11, v12, 1, v11
    s_lshl_b32 s5, s6, 7
    s_add_u32 s5, s5, 0xb400
    v_add_u32 v11, s5, v11
    s_mul_i32 s5, s6, 1040
    s_add_u32 s5, s5, 0xb400
    v_add_u32 v12, s5, v8
    s_lshl_b32 s35, s6, 2
    s_add_u32 s35, s35, 0xac00
    v_mov_b32 v15, s35
    v_and_b32 v14, 7, v0
    v_lshlrev_b32_e64 v14, 2, v14
    v_add_u32 v14, 0xac00, v14
    s_waitcnt lgkmcnt(0)
    s_barrier
    ds_read_b32 v248, v4
    ds_read2st64_b32 v[240:241], v3 offset0:0 offset1:10
    ds_read2st64_b32 v[242:243], v3 offset0:20 offset1:30
    ds_read2st64_b32 v[244:245], v3 offset0:40 offset1:50
    ds_read2st64_b32 v[246:247], v3 offset0:60 offset1:70
    s_waitcnt lgkmcnt(0)
    v_add_f32_dpp v248, v248, v248 quad_perm:[1,0,3,2] row_mask:0xf bank_mask:0xf
    v_pk_add_f32 v[240:241], v[240:241], v[242:243]
    v_pk_add_f32 v[244:245], v[244:245], v[246:247]
    v_add_f32_dpp v248, v248, v248 quad_perm:[2,3,0,1] row_mask:0xf bank_mask:0xf
    v_pk_add_f32 v[240:241], v[240:241], v[244:245]
    v_add_f32 v240, v240, v241
    v_add_f32_dpp v248, v248, v248 row_half_mirror row_mask:0xf bank_mask:0xf
    v_rcp_f32_e64 v241, v248
    v_maximum3_f32 v7, v7, v248, abs(v240)
    v_mul_f32_e64 v240, v240, v241
    v_cvt_pk_bf16_f32 v240, v240, v240
    ds_write_b16 v5, v240
    v_mov_b32 v13, 0x7d800000
    v_cmp_nlt_f32 vcc, v7, v13
    s_cmp_lg_u64 vcc, 0
    s_cselect_b32 s5, 1, 0
    v_mov_b32 v13, s5
    ds_write_b32 v15, v13 offset:32
    s_waitcnt vmcnt(2) lgkmcnt(0)
    s_barrier
    ds_read_b128 v[236:239], v6
    ds_read_b32 v13, v14 offset:32
    s_waitcnt lgkmcnt(1)
    v_smfmac_f32_16x16x64_bf16 v[188:191], v[236:239], v[204:211], v183
    v_smfmac_f32_16x16x64_bf16 v[192:195], v[236:239], v[212:219], v183
    v_smfmac_f32_16x16x64_bf16 v[196:199], v[236:239], v[220:227], v183
    v_smfmac_f32_16x16x64_bf16 v[200:203], v[236:239], v[228:235], v183
    s_waitcnt lgkmcnt(0)
    v_cmp_ne_u32 vcc, 0, v13
    s_cmp_eq_u64 vcc, 0
    s_cbranch_scc1 K2_good
    s_cmp_lg_u32 s30, 0
    s_cbranch_scc1 K2_good
    s_mov_b32 s30, 1
    s_waitcnt vmcnt(0)
    s_setprio 0
    s_branch K2_restart
K2_good:
    s_nop 4
    v_permlane32_swap_b32 v188, v190
    v_permlane32_swap_b32 v189, v191
    v_pk_add_f32 v[188:189], v[188:189], v[190:191]
    v_cvt_pk_bf16_f32 v240, v188, v189
    ds_write_b16 v11, v240 offset:0
    ds_write_b16_d16_hi v11, v240 offset:1040
    v_permlane32_swap_b32 v192, v194
    v_permlane32_swap_b32 v193, v195
    v_pk_add_f32 v[192:193], v[192:193], v[194:195]
    v_cvt_pk_bf16_f32 v241, v192, v193
    ds_write_b16 v11, v241 offset:32
    ds_write_b16_d16_hi v11, v241 offset:1072
    v_permlane32_swap_b32 v196, v198
    v_permlane32_swap_b32 v197, v199
    v_pk_add_f32 v[196:197], v[196:197], v[198:199]
    v_cvt_pk_bf16_f32 v242, v196, v197
    ds_write_b16 v11, v242 offset:64
    ds_write_b16_d16_hi v11, v242 offset:1104
    v_permlane32_swap_b32 v200, v202
    v_permlane32_swap_b32 v201, v203
    v_pk_add_f32 v[200:201], v[200:201], v[202:203]
    v_cvt_pk_bf16_f32 v243, v200, v201
    ds_write_b16 v11, v243 offset:96
    ds_write_b16_d16_hi v11, v243 offset:1136
    s_waitcnt vmcnt(0)
    v_lshlrev_b32 v112, 16, v160
    v_and_b32 v113, 0xffff0000, v160
    v_lshlrev_b32_e64 v114, 16, v161
    v_and_b32 v115, 0xffff0000, v161
    v_lshlrev_b32_e64 v116, 16, v162
    v_and_b32 v117, 0xffff0000, v162
    v_lshlrev_b32_e64 v118, 16, v163
    v_and_b32 v119, 0xffff0000, v163
    s_waitcnt lgkmcnt(0)
    s_barrier
    ds_read_b128 v[236:239], v12
    s_waitcnt lgkmcnt(0)
    v_lshlrev_b32 v120, 16, v236
    v_and_b32 v121, 0xffff0000, v236
    v_lshlrev_b32_e64 v122, 16, v237
    v_and_b32 v123, 0xffff0000, v237
    v_lshlrev_b32_e64 v124, 16, v238
    v_and_b32 v125, 0xffff0000, v238
    v_lshlrev_b32_e64 v126, 16, v239
    v_and_b32 v127, 0xffff0000, v239
    v_pk_add_f32 v[112:113], v[112:113], v[120:121]
    v_pk_add_f32 v[114:115], v[114:115], v[122:123]
    v_pk_add_f32 v[116:117], v[116:117], v[124:125]
    v_pk_add_f32 v[118:119], v[118:119], v[126:127]
    v_cvt_pk_bf16_f32 v112, 0, v112
    v_cvt_pk_bf16_f32 v113, 0, v113
    v_cvt_pk_bf16_f32 v114, 0, v114
    v_cvt_pk_bf16_f32 v115, 0, v115
    v_cvt_pk_bf16_f32 v116, 0, v116
    v_cvt_pk_bf16_f32 v117, 0, v117
    v_cvt_pk_bf16_f32 v118, 0, v118
    v_cvt_pk_bf16_f32 v119, 0, v119
    v_pk_add_f32 v[240:241], v[112:113], v[114:115]
    v_pk_mul_f32 v[242:243], v[112:113], v[112:113]
    v_pk_add_f32 v[244:245], v[116:117], v[118:119]
    v_pk_fma_f32 v[242:243], v[114:115], v[114:115], v[242:243]
    v_pk_add_f32 v[240:241], v[240:241], v[244:245]
    v_pk_fma_f32 v[242:243], v[116:117], v[116:117], v[242:243]
    v_add_f32_e64 v11, v240, v241
    v_pk_fma_f32 v[242:243], v[118:119], v[118:119], v[242:243]
    v_add_f32_e64 v13, v242, v243
    v_add_f32_dpp v11, v11, v11 quad_perm:[1,0,3,2] row_mask:0xf bank_mask:0xf
    s_nop 0
    v_add_f32_dpp v13, v13, v13 quad_perm:[1,0,3,2] row_mask:0xf bank_mask:0xf
    v_add_f32_dpp v11, v11, v11 quad_perm:[2,3,0,1] row_mask:0xf bank_mask:0xf
    s_nop 0
    v_add_f32_dpp v13, v13, v13 quad_perm:[2,3,0,1] row_mask:0xf bank_mask:0xf
    v_add_f32_dpp v11, v11, v11 row_half_mirror row_mask:0xf bank_mask:0xf
    s_nop 0
    v_add_f32_dpp v13, v13, v13 row_half_mirror row_mask:0xf bank_mask:0xf
    v_add_f32_dpp v11, v11, v11 row_mirror row_mask:0xf bank_mask:0xf
    s_nop 0
    v_add_f32_dpp v13, v13, v13 row_mirror row_mask:0xf bank_mask:0xf
    v_mov_b32 v136, v11
    v_mov_b32 v137, v13
    s_nop 0
    v_permlane16_swap_b32 v136, v11
    v_permlane16_swap_b32 v137, v13
    v_add_f32 v11, v11, v136
    v_add_f32 v13, v13, v137
    v_mov_b32 v136, v11
    v_mov_b32 v137, v13
    s_nop 0
    v_permlane32_swap_b32 v136, v11
    v_permlane32_swap_b32 v137, v13
    v_add_f32 v11, v11, v136
    v_add_f32 v13, v13, v137
    v_mul_f32 v137, 0x3b000000, v11
    v_mul_f32 v139, 0x3b000000, v13
    v_fma_f32 v139, -v137, v137, v139
    v_max_f32_e64 v139, 0, v139
    v_cvt_pk_bf16_f32 v136, 0, v137
    v_cvt_pk_bf16_f32 v139, 0, v139
    v_add_f32 v139, 0x3727c5ac, v139
    v_cvt_pk_bf16_f32 v139, 0, v139
    v_sqrt_f32 v139, v139
    s_nop 0
    v_cvt_pk_bf16_f32 v139, 0, v139
    v_rcp_f32_e64 v138, v139
    v_pk_add_f32 v[120:121], v[112:113], v[136:137] op_sel_hi:[1,0] neg_lo:[0,1] neg_hi:[0,1]
    v_pk_add_f32 v[122:123], v[114:115], v[136:137] op_sel_hi:[1,0] neg_lo:[0,1] neg_hi:[0,1]
    v_pk_add_f32 v[124:125], v[116:117], v[136:137] op_sel_hi:[1,0] neg_lo:[0,1] neg_hi:[0,1]
    v_pk_add_f32 v[126:127], v[118:119], v[136:137] op_sel_hi:[1,0] neg_lo:[0,1] neg_hi:[0,1]
    v_cvt_pk_bf16_f32 v120, 0, v120
    v_cvt_pk_bf16_f32 v121, 0, v121
    v_cvt_pk_bf16_f32 v122, 0, v122
    v_cvt_pk_bf16_f32 v123, 0, v123
    v_cvt_pk_bf16_f32 v124, 0, v124
    v_cvt_pk_bf16_f32 v125, 0, v125
    v_cvt_pk_bf16_f32 v126, 0, v126
    v_cvt_pk_bf16_f32 v127, 0, v127
    v_pk_mul_f32 v[120:121], v[120:121], v[138:139] op_sel_hi:[1,0]
    v_pk_mul_f32 v[122:123], v[122:123], v[138:139] op_sel_hi:[1,0]
    v_pk_mul_f32 v[124:125], v[124:125], v[138:139] op_sel_hi:[1,0]
    v_pk_mul_f32 v[126:127], v[126:127], v[138:139] op_sel_hi:[1,0]
    v_cvt_pk_bf16_f32 v140, v120, v121
    v_cvt_pk_bf16_f32 v141, v122, v123
    v_cvt_pk_bf16_f32 v142, v124, v125
    v_cvt_pk_bf16_f32 v143, v126, v127
    v_dot2_f32_bf16 v13, v140, v164, 0
    v_dot2_f32_bf16 v13, v141, v165, v13
    v_dot2_f32_bf16 v13, v142, v166, v13
    v_dot2_f32_bf16 v13, v143, v167, v13
    v_cvt_pk_bf16_f32 v132, v112, v113
    v_lshlrev_b32_e64 v120, 16, v140
    v_and_b32 v121, 0xffff0000, v140
    v_add_f32_dpp v13, v13, v13 quad_perm:[1,0,3,2] row_mask:0xf bank_mask:0xf
    v_lshlrev_b32_e64 v122, 16, v141
    v_and_b32 v123, 0xffff0000, v141
    v_add_f32_dpp v13, v13, v13 quad_perm:[2,3,0,1] row_mask:0xf bank_mask:0xf
    v_lshlrev_b32_e64 v124, 16, v142
    v_and_b32 v125, 0xffff0000, v142
    v_add_f32_dpp v13, v13, v13 row_half_mirror row_mask:0xf bank_mask:0xf
    v_lshlrev_b32_e64 v126, 16, v143
    v_and_b32 v127, 0xffff0000, v143
    v_add_f32_dpp v13, v13, v13 row_mirror row_mask:0xf bank_mask:0xf
    v_mov_b32_e64 v11, v13
    v_pk_add_f32 v[212:213], v[112:113], v[120:121]
    v_pk_add_f32 v[214:215], v[114:115], v[122:123]
    v_permlane16_swap_b32 v11, v13
    v_add_f32 v13, v13, v11
    v_mov_b32_e64 v11, v13
    v_pk_add_f32 v[216:217], v[116:117], v[124:125]
    v_pk_add_f32 v[218:219], v[118:119], v[126:127]
    v_permlane32_swap_b32 v11, v13
    v_add_f32 v13, v13, v11
    v_cvt_pk_bf16_f32 v13, 0, v13
    v_ashrrev_i32_e64 v11, 31, v13
    v_or_b32 v11, 0x80000000, v11
    v_xor_b32_e64 v13, v13, v11
    v_and_b32 v13, 0xffff0000, v13
    s_sub_u32 s5, 0xffff, s3
    v_or_b32_e64 v13, s5, v13
    ds_write_b32 v15, v13
    v_cvt_pk_bf16_f32 v128, v212, v213
    v_cvt_pk_bf16_f32 v129, v214, v215
    v_cvt_pk_bf16_f32 v130, v216, v217
    v_cvt_pk_bf16_f32 v131, v218, v219
    buffer_store_dwordx4 v[128:131], v8, s[20:23], s4 offen sc1
    v_cvt_pk_bf16_f32 v133, v114, v115
    v_cvt_pk_bf16_f32 v134, v116, v117
    v_cvt_pk_bf16_f32 v135, v118, v119
    v_min_u32 v132, -2, v132
    v_min_u32 v140, -2, v140
    v_min_u32 v133, -2, v133
    v_min_u32 v141, -2, v141
    v_min_u32 v134, -2, v134
    v_min_u32 v142, -2, v142
    v_min_u32 v135, -2, v135
    v_min_u32 v143, -2, v143
    s_waitcnt lgkmcnt(0)
    s_barrier
    ds_read_b32 v12, v14
    s_waitcnt lgkmcnt(0)
    v_cmp_gt_u32 vcc, v12, v13
    v_cmp_eq_u32 s[36:37], v12, v13
    s_and_b32 s38, vcc_lo, 0xff
    s_bcnt1_i32_b32 s38, s38
    s_cmp_gt_u32 s38, 1
    s_cbranch_scc1 K2_pub
    s_lshl_b32 s34, s7, 9
    s_lshl_b32 s5, s38, 11
    s_add_u32 s34, s34, s5
    s_add_u32 s34, s34, 0x300000
    buffer_store_dwordx4 v[140:143], v8, s[8:11], s34 offen sc1
    s_cmp_lg_u32 s38, 0
    s_cbranch_scc1 K2_pub0
    v_cndmask_b32 v137, v12, 0, s[36:37]
    v_mov_b32 v136, v13
    s_lshl_b32 s5, s2, 6
    s_add_u32 s5, s5, 0x2c0000
    v_lshlrev_b32_e64 v11, 14, v0
    v_max_u32_dpp v137, v137, v137 quad_perm:[1,0,3,2] row_mask:0xf bank_mask:0xf
    s_nop 1
    v_max_u32_dpp v137, v137, v137 quad_perm:[2,3,0,1] row_mask:0xf bank_mask:0xf
    s_nop 1
    v_max_u32_dpp v137, v137, v137 row_half_mirror row_mask:0xf bank_mask:0xf
    v_xor_b32 v137, 0x800, v137
    s_mov_b64 exec, 255
    buffer_store_dwordx2 v[136:137], v11, s[8:11], s5 offen sc1
    s_mov_b64 exec, -1
K2_pub0:
    s_waitcnt vmcnt(0)
    buffer_store_dwordx4 v[132:135], v8, s[8:11], s34 offen offset:1024 sc1
K2_pub:
    s_cmp_ge_u32 s2, 144
    s_cbranch_scc1 K2_fin
    s_setprio 0
    v_bfe_u32 v11, v0, 2, 2
    v_lshrrev_b32_e64 v15, 4, v0
    v_lshl_add_u32 v11, v15, 3, v11
    v_lshlrev_b32 v11, 5, v11
    v_and_b32 v12, 3, v0
    v_lshl_add_u32 v11, v12, 3, v11
    v_add_u32_e64 v11, s74, v11
    ds_read_b64_tr_b16 v[48:49], v11 offset:0
    ds_read_b64_tr_b16 v[50:51], v11 offset:128
    ds_read_b64_tr_b16 v[52:53], v11 offset:1024
    ds_read_b64_tr_b16 v[54:55], v11 offset:1152
    ds_read_b64_tr_b16 v[56:57], v11 offset:2048
    ds_read_b64_tr_b16 v[58:59], v11 offset:2176
    ds_read_b64_tr_b16 v[60:61], v11 offset:3072
    ds_read_b64_tr_b16 v[62:63], v11 offset:3200
    ds_read_b64_tr_b16 v[64:65], v11 offset:4096
    ds_read_b64_tr_b16 v[66:67], v11 offset:4224
    ds_read_b64_tr_b16 v[68:69], v11 offset:5120
    ds_read_b64_tr_b16 v[70:71], v11 offset:5248
    ds_read_b64_tr_b16 v[72:73], v11 offset:6144
    ds_read_b64_tr_b16 v[74:75], v11 offset:6272
    v_and_b32 v14, 1, v0
    v_lshlrev_b32 v2, 6, v14
    v_lshl_add_u32 v2, v15, 4, v2
    s_lshl_b32 s5, s6, 7
    s_add_u32 s5, s5, 0x1000
    v_add_u32 v2, s5, v2
    v_and_b32 v3, 31, v0
    v_lshlrev_b32 v3, 2, v3
    v_lshrrev_b32_e64 v6, 5, v0
    v_lshl_add_u32 v6, v6, 14, v3
    s_cmp_lg_u32 s38, 2
    s_cbranch_scc1 K2_nokey
    v_lshlrev_b32_e64 v12, 6, v0
    s_and_b32 s5, s2, 7
    s_lshl_b32 s5, s5, 14
    s_add_u32 s5, s5, 0x2c0000
    s_add_u32 s79, s5, 4096
    s_add_u32 s80, s5, 8192
    s_add_u32 s81, s5, 12288
    s_mov_b32 s36, 0
    s_sleep 12
    buffer_load_dwordx2 v[16:17], v12, s[8:11], s5 offen sc1
    buffer_load_dwordx2 v[18:19], v12, s[8:11], s79 offen sc1
    buffer_load_dwordx2 v[20:21], v12, s[8:11], s80 offen sc1
    buffer_load_dwordx2 v[22:23], v12, s[8:11], s81 offen sc1
    s_sleep 3
K2_kp_l:
    buffer_load_dwordx2 v[112:113], v12, s[8:11], s5 offen sc1
    buffer_load_dwordx2 v[114:115], v12, s[8:11], s79 offen sc1
    buffer_load_dwordx2 v[116:117], v12, s[8:11], s80 offen sc1
    buffer_load_dwordx2 v[118:119], v12, s[8:11], s81 offen sc1
    s_waitcnt vmcnt(4)
    v_min3_u32 v24, v16, v17, v18
    v_min3_u32 v25, v19, v20, v21
    v_min3_u32 v24, v24, v22, v23
    v_min_u32_e64 v24, v24, v25
    v_cmp_eq_u32 vcc, 0, v24
    s_cbranch_vccz K2_kp_ok
    buffer_load_dwordx2 v[16:17], v12, s[8:11], s5 offen sc1
    buffer_load_dwordx2 v[18:19], v12, s[8:11], s79 offen sc1
    buffer_load_dwordx2 v[20:21], v12, s[8:11], s80 offen sc1
    buffer_load_dwordx2 v[22:23], v12, s[8:11], s81 offen sc1
    s_waitcnt vmcnt(4)
    v_min3_u32 v24, v112, v113, v114
    v_min3_u32 v25, v115, v116, v117
    v_min3_u32 v24, v24, v118, v119
    v_min_u32 v24, v24, v25
    v_cmp_eq_u32 vcc, 0, v24
    s_cbranch_vccz K2_kp_ok2
    s_add_u32 s36, s36, 1
    s_cmp_lt_u32 s36, 0x40000
    s_cbranch_scc1 K2_kp_l
K2_kp_ok2:
    v_pk_mov_b32 v[16:17], v[112:113], v[112:113] op_sel:[0,1]
    v_pk_mov_b32 v[18:19], v[114:115], v[114:115] op_sel:[0,1]
    v_pk_mov_b32 v[20:21], v[116:117], v[116:117] op_sel:[0,1]
    v_pk_mov_b32 v[22:23], v[118:119], v[118:119] op_sel:[0,1]
K2_kp_ok:
K2_kok:
    v_max_u32 v28, v16, v18
    v_min_u32 v29, v16, v18
    v_max3_u32 v29, v29, v17, v19
    v_max_u32 v24, v20, v22
    v_min_u32 v25, v20, v22
    v_max3_u32 v25, v25, v21, v23
    v_min_u32 v26, v28, v24
    v_max_u32 v28, v28, v24
    v_max3_u32 v29, v29, v25, v26
    v_mov_b32 v24, v28
    s_nop 1
    v_max_u32_dpp v24, v24, v24 quad_perm:[1,0,3,2] row_mask:0xf bank_mask:0xf
    s_nop 1
    v_max_u32_dpp v24, v24, v24 quad_perm:[2,3,0,1] row_mask:0xf bank_mask:0xf
    s_nop 1
    v_max_u32_dpp v24, v24, v24 row_half_mirror row_mask:0xf bank_mask:0xf
    s_nop 1
    v_max_u32_dpp v24, v24, v24 row_mirror row_mask:0xf bank_mask:0xf
    v_mov_b32 v25, v24
    s_nop 1
    v_permlane16_swap_b32 v25, v24
    v_max_u32 v24, v24, v25
    v_mov_b32 v25, v24
    s_nop 1
    v_permlane32_swap_b32 v25, v24
    v_max_u32_e64 v24, v24, v25
    v_cmp_eq_u32 vcc, v28, v24
    s_nop 1
    v_cndmask_b32 v28, v28, v29, vcc
    s_nop 1
    v_max_u32_dpp v28, v28, v28 quad_perm:[1,0,3,2] row_mask:0xf bank_mask:0xf
    s_nop 1
    v_max_u32_dpp v28, v28, v28 quad_perm:[2,3,0,1] row_mask:0xf bank_mask:0xf
    s_nop 1
    v_max_u32_dpp v28, v28, v28 row_half_mirror row_mask:0xf bank_mask:0xf
    s_nop 1
    v_max_u32_dpp v28, v28, v28 row_mirror row_mask:0xf bank_mask:0xf
    v_mov_b32 v25, v28
    s_nop 1
    v_permlane16_swap_b32 v25, v28
    v_max_u32 v28, v28, v25
    v_mov_b32 v25, v28
    s_nop 1
    v_permlane32_swap_b32 v25, v28
    v_max_u32_e64 v28, v28, v25
    v_readfirstlane_b32 s40, v24
    v_readfirstlane_b32 s41, v28
    s_andn2_b32 s42, 0x7ff, s40
    s_andn2_b32 s43, 0x7ff, s41
    s_lshr_b32 s50, s42, 3
    s_lshr_b32 s51, s43, 3
    s_lshl_b32 s50, s50, 12
    s_lshl_b32 s51, s51, 12
    s_andn2_b32 s52, 0x800, s40
    s_andn2_b32 s53, 0x800, s41
    s_add_u32 s50, s50, s52
    s_add_u32 s51, s51, s53
    s_lshl_b32 s42, s42, 10
    s_lshl_b32 s43, s43, 10
K2_nokey:
    s_cmp_ge_u32 s2, 112
    s_cbranch_scc1 K2_down
    s_cmp_lg_u32 s38, 2
    s_cbranch_scc1 K2_up1
    s_add_u32 s50, s50, 0x300000
    s_add_u32 s51, s51, 0x300000
    s_mov_b32 s36, 0
K2_rows:
    buffer_load_dwordx4 v[16:19], v8, s[8:11], s50 offen sc1
    buffer_load_dwordx4 v[20:23], v8, s[8:11], s51 offen sc1
    s_add_u32 s36, s36, 1
    s_waitcnt vmcnt(1)
    ds_write_b128 v8, v[16:19] offset:0
    v_max3_u32 v24, v16, v17, v18
    s_waitcnt vmcnt(0)
    ds_write_b128 v8, v[20:23] offset:1040
    v_max3_u32 v25, v19, v20, v21
    v_max3_u32 v24, v24, v22, v23
    v_max_u32 v24, v24, v25
    v_cmp_eq_u32 vcc, -1, v24
    s_cbranch_vccz K2_up1
    s_cmp_lt_u32 s36, 0x40000
    s_cbranch_scc1 K2_rows
K2_up1:
    v_mul_u32_u24 v11, 1040, v14
    v_lshl_add_u32 v11, v15, 4, v11
    s_lshr_b32 s5, s6, 1
    s_lshl_b32 s5, s5, 8
    v_add_u32 v11, s5, v11
    s_waitcnt lgkmcnt(0)
    s_barrier
    ds_read_b128 v[80:83], v11 offset:0
    ds_read_b128 v[84:87], v11 offset:64
    ds_read_b128 v[88:91], v11 offset:128
    ds_read_b128 v[92:95], v11 offset:192
    s_waitcnt lgkmcnt(3)
    v_mfma_f32_16x16x32_bf16 v[32:35], v[48:51], v[80:83], 0
    s_waitcnt lgkmcnt(2)
    v_mfma_f32_16x16x32_bf16 v[32:35], v[52:55], v[84:87], v[32:35]
    s_waitcnt lgkmcnt(1)
    v_mfma_f32_16x16x32_bf16 v[32:35], v[56:59], v[88:91], v[32:35]
    s_waitcnt lgkmcnt(0)
    v_mfma_f32_16x16x32_bf16 v[32:35], v[60:63], v[92:95], v[32:35]
    s_nop 7
    ds_write_b128 v2, v[32:35]
    s_waitcnt lgkmcnt(0)
    s_barrier
    s_cmp_lg_u32 s38, 2
    s_cbranch_scc1 K2_fin
    v_add_u32 v11, 0x1000, v3
    s_waitcnt vmcnt(0)
    ds_read2_b32 v[16:17], v11 offset0:0 offset1:32
    ds_read2_b32 v[18:19], v11 offset0:64 offset1:96
    ds_read2_b32 v[20:21], v11 offset0:128 offset1:160
    ds_read2_b32 v[22:23], v11 offset0:192 offset1:224
    s_waitcnt lgkmcnt(0)
    s_nop 0
    v_pk_add_f32 v[16:17], v[16:17], v[18:19]
    v_pk_add_f32 v[20:21], v[20:21], v[22:23]
    v_pk_add_f32 v[16:17], v[16:17], v[20:21]
    v_cvt_pk_bf16_f32 v16, 0, v16
    v_cvt_pk_bf16_f32 v17, 0, v17
    v_mul_f32 v19, 0xbfb8aa3b, v16
    v_exp_f32 v19, v19
    s_nop 0
    v_add_f32 v19, 1.0, v19
    v_rcp_f32 v18, v19
    s_nop 0
    v_mul_f32 v16, v16, v18
    v_cvt_pk_bf16_f32 v16, 0, v16
    v_mul_f32_e64 v16, v16, v17
    v_cvt_pk_bf16_f32 v16, 0, v16
    v_or_b32 v16, 1, v16
    s_lshl_b32 s5, s76, 7
    s_add_u32 s5, s5, 0x2a0000
    buffer_store_dword v16, v6, s[8:11], s5 offen sc1
    s_add_u32 s5, s5, 0x8000
    buffer_store_dword v16, v6, s[8:11], s5 offen sc1
    s_add_u32 s5, s5, 0x8000
    buffer_store_dword v16, v6, s[8:11], s5 offen sc1
    s_add_u32 s5, s5, 0x8000
    buffer_store_dword v16, v6, s[8:11], s5 offen sc1
    s_branch K2_fin
K2_down:
    s_cmp_lg_u32 s38, 2
    s_cbranch_scc1 K2_dn1
    v_bfe_u32 v11, v0, 4, 1
    v_cmp_eq_u32 vcc, 0, v11
    v_mov_b32 v11, s43
    v_mov_b32 v12, s42
    v_cndmask_b32 v37, v11, v12, vcc
    v_and_b32 v11, 15, v0
    v_lshl_add_u32 v37, v11, 1, v37
    s_lshl_b32 s44, s77, 5
    v_mov_b32 v12, s51
    v_mov_b32 v38, s50
    v_cndmask_b32 v38, v12, v38, vcc
    v_and_b32_e64 v11, 14, v0
    v_lshl_add_u32 v38, v11, 1, v38
    s_add_u32 s52, s44, 0x300000
    v_mov_b32_e64 v11, s41
    v_mov_b32 v12, s40
    v_cndmask_b32 v36, v11, v12, vcc
    v_and_b32 v36, 0xffff0000, v36
    v_ashrrev_i32 v11, 31, v36
    v_not_b32 v11, v11
    v_or_b32 v11, 0x80000000, v11
    v_xor_b32_e64 v36, v36, v11
    v_and_b32 v36, 0xffff0000, v36
    v_mul_f32 v11, 0xbfb8aa3b, v36
    v_exp_f32 v11, v11
    s_nop 0
    v_add_f32_e64 v11, 1.0, v11
    v_rcp_f32 v36, v11
    s_nop 0
    v_cvt_pk_bf16_f32 v36, 0, v36
K2_dn1:
    s_mul_i32 s5, s6, 1792
    s_and_b32 s37, s2, 7
    s_lshl_b32 s37, s37, 14
    s_add_u32 s5, s5, s37
    s_add_u32 s5, s5, 0x2a0000
    v_min_u32 v12, 47, v0
    v_lshlrev_b32 v12, 4, v12
    s_lshl_b32 s37, s6, 10
    s_add_u32 s37, s37, 0x2000
    v_lshrrev_b32 v11, 3, v0
    v_lshlrev_b32 v4, 5, v11
    v_and_b32_e64 v11, 3, v0
    v_lshl_add_u32 v4, v11, 3, v4
    v_bfe_u32 v11, v0, 2, 1
    v_mul_u32_u24 v11, 464, v11
    v_add3_u32 v4, v4, v11, s37
    v_mul_u32_u24 v5, 464, v14
    v_lshl_add_u32 v5, v15, 4, v5
    v_add_u32_e64 v5, s37, v5
    s_mov_b32 s45, 0x07060302
    s_mov_b32 s36, 0
    s_barrier
    s_cmp_lg_u32 s38, 2
    s_cbranch_scc1 K2_hw
K2_hl:
    buffer_load_dword v31, v38, s[8:11], s52 offen sc1
    buffer_load_dword v30, v38, s[8:11], s52 offen offset:1024 sc1
    s_add_u32 s36, s36, 1
    s_waitcnt vmcnt(0)
    v_max_u32_e64 v11, v30, v31
    v_cmp_eq_u32 vcc, -1, v11
    s_cbranch_vccz K2_hok
    s_cmp_lt_u32 s36, 0x40000
    s_cbranch_scc1 K2_hl
K2_hok:
    v_and_b32 v11, 1, v0
    v_lshlrev_b32 v11, 4, v11
    v_lshrrev_b32 v30, v11, v30
    v_lshrrev_b32_e64 v31, v11, v31
    s_mov_b32 s36, 0
    s_sleep 14
    s_branch K2_hx
K2_hw:
    s_sleep 28
K2_hx:
    buffer_load_dwordx4 v[16:19], v8, s[8:11], s5 offen sc1
    buffer_load_dwordx4 v[20:23], v12, s[8:11], s5 offen offset:1024 sc1
    s_sleep 3
K2_gp_l:
    buffer_load_dwordx4 v[112:115], v8, s[8:11], s5 offen sc1
    buffer_load_dwordx4 v[116:119], v12, s[8:11], s5 offen offset:1024 sc1
    s_waitcnt vmcnt(2)
    v_min3_u32 v24, v16, v17, v18
    v_min3_u32 v25, v19, v20, v21
    v_min3_u32 v24, v24, v22, v23
    v_min_u32_e64 v24, v24, v25
    v_cmp_eq_u32 vcc, 0, v24
    s_cbranch_vccz K2_gp_ok
    buffer_load_dwordx4 v[16:19], v8, s[8:11], s5 offen sc1
    buffer_load_dwordx4 v[20:23], v12, s[8:11], s5 offen offset:1024 sc1
    s_waitcnt vmcnt(2)
    v_min3_u32 v24, v112, v113, v114
    v_min3_u32 v25, v115, v116, v117
    v_min3_u32 v24, v24, v118, v119
    v_min_u32 v24, v24, v25
    v_cmp_eq_u32 vcc, 0, v24
    s_cbranch_vccz K2_gp_ok2
    s_add_u32 s36, s36, 1
    s_cmp_lt_u32 s36, 0x40000
    s_cbranch_scc1 K2_gp_l
K2_gp_ok2:
    v_pk_mov_b32 v[16:17], v[112:113], v[112:113] op_sel:[0,1]
    v_pk_mov_b32 v[18:19], v[114:115], v[114:115] op_sel:[0,1]
    v_pk_mov_b32 v[20:21], v[116:117], v[116:117] op_sel:[0,1]
    v_pk_mov_b32 v[22:23], v[118:119], v[118:119] op_sel:[0,1]
K2_gp_ok:
K2_gok:
    v_perm_b32 v24, v17, v16, s45
    v_perm_b32 v25, v19, v18, s45
    v_perm_b32 v26, v21, v20, s45
    v_perm_b32 v27, v23, v22, s45
    ds_write_b64 v4, v[24:25]
    s_mov_b32 exec_hi, 0xffff
    ds_write_b64 v4, v[26:27] offset:256
    s_mov_b64 exec, -1
    s_nop 0
    ds_read_b128 v[80:83], v5 offset:0
    ds_read_b128 v[84:87], v5 offset:64
    ds_read_b128 v[88:91], v5 offset:128
    ds_read_b128 v[92:95], v5 offset:192
    ds_read_b128 v[96:99], v5 offset:256
    ds_read_b128 v[100:103], v5 offset:320
    ds_read_b128 v[104:107], v5 offset:384
    s_waitcnt lgkmcnt(6)
    v_mfma_f32_16x16x32_bf16 v[32:35], v[48:51], v[80:83], 0
    s_waitcnt lgkmcnt(5)
    v_mfma_f32_16x16x32_bf16 v[32:35], v[52:55], v[84:87], v[32:35]
    s_waitcnt lgkmcnt(4)
    v_mfma_f32_16x16x32_bf16 v[32:35], v[56:59], v[88:91], v[32:35]
    s_waitcnt lgkmcnt(3)
    v_mfma_f32_16x16x32_bf16 v[32:35], v[60:63], v[92:95], v[32:35]
    s_waitcnt lgkmcnt(2)
    v_mfma_f32_16x16x32_bf16 v[32:35], v[64:67], v[96:99], v[32:35]
    s_waitcnt lgkmcnt(1)
    v_mfma_f32_16x16x32_bf16 v[32:35], v[68:71], v[100:103], v[32:35]
    s_waitcnt lgkmcnt(0)
    v_mfma_f32_16x16x32_bf16 v[32:35], v[72:75], v[104:107], v[32:35]
    s_nop 7
    ds_write_b128 v2, v[32:35]
    s_waitcnt lgkmcnt(0)
    s_barrier
    s_cmp_lg_u32 s38, 2
    s_cbranch_scc1 K2_fin
    v_add_u32 v11, 0x1000, v3
    s_waitcnt vmcnt(0)
    ds_read2_b32 v[16:17], v11 offset0:0 offset1:32
    ds_read2_b32 v[18:19], v11 offset0:64 offset1:96
    ds_read2_b32 v[20:21], v11 offset0:128 offset1:160
    ds_read2_b32 v[22:23], v11 offset0:192 offset1:224
    s_waitcnt lgkmcnt(0)
    v_pk_add_f32 v[16:17], v[16:17], v[18:19]
    v_pk_add_f32 v[20:21], v[20:21], v[22:23]
    v_pk_add_f32 v[16:17], v[16:17], v[20:21]
    v_add_f32 v16, v16, v17
    v_lshlrev_b32 v30, 16, v30
    v_lshlrev_b32_e64 v31, 16, v31
    v_cvt_pk_bf16_f32 v16, 0, v16
    v_mul_f32_e64 v16, v16, v36
    v_cvt_pk_bf16_f32 v16, 0, v16
    v_add_f32_e64 v16, v16, v31
    v_cvt_pk_bf16_f32 v16, 0, v16
    v_add_f32_e64 v16, v16, v30
    v_cvt_pk_bf16_f32 v16, v16, v16
    s_mov_b32 exec_hi, 0
    buffer_store_short v16, v37, s[20:23], s44 offen sc1
    s_mov_b64 exec, -1
K2_fin:
K2_end:
    s_endpgm
K2_side:
    buffer_load_dword v182, v181, s[12:15], s38 offen
    s_branch K2_sideb
K2_stg:
    s_mov_b32 m0, s78
    s_add_u32 s78, s78, 1024
    buffer_load_dwordx4 v180, s[68:71], s72 offen lds
    s_add_u32 s72, s72, s73
    s_bitcmp1_b32 s42, s29
    s_cbranch_scc0 K2_stgb
    s_mov_b32 m0, s78
    s_add_u32 s78, s78, 1024
    buffer_load_dwordx4 v180, s[68:71], s72 offen lds
    s_add_u32 s72, s72, s73
    s_branch K2_stgb
K2_rtm:
    s_mov_b32 s36, 0
K2_rlm:
    buffer_load_dwordx4 v[16:19], v8, s[8:11], s50 offen sc1
    buffer_load_dwordx4 v[20:23], v8, s[8:11], s51 offen sc1
    s_add_u32 s36, s36, 1
    s_waitcnt vmcnt(0)
    v_max_u32_e64 v182, v16, v20
    v_cmp_eq_u32 vcc, -1, v182
    s_cbranch_vccz K2_rbm
    s_cmp_lt_u32 s36, 0x40000
    s_cbranch_scc1 K2_rlm
    s_branch K2_rbm
K2_rts:
    s_mov_b32 s36, 0
K2_rls:
    buffer_load_dwordx4 v[16:19], v8, s[8:11], s50 offen sc1
    s_add_u32 s36, s36, 1
    s_waitcnt vmcnt(0)
    v_cmp_eq_u32 vcc, -1, v16
    s_cbranch_vccz K2_rbs
    s_cmp_lt_u32 s36, 0x40000
    s_cbranch_scc1 K2_rls
    s_branch K2_rbs
K2_rt0:
    s_mov_b32 s36, 0
K2_rl0:
    buffer_load_dwordx4 v[20:23], v8, s[8:11], s51 offen sc1
    buffer_load_dwordx4 v[48:51], v10, s[8:11], s50 offen offset:1024 sc1
    buffer_load_dwordx4 v[52:55], v10, s[8:11], s50 offen offset:1568 sc1
    s_add_u32 s36, s36, 1
    s_waitcnt vmcnt(0)
    v_max3_u32 v182, v20, v48, v52
    v_cmp_eq_u32 vcc, -1, v182
    s_cbranch_vccz K2_rb0
    s_cmp_lt_u32 s36, 0x40000
    s_cbranch_scc1 K2_rl0
    s_branch K2_rb0
K2_rt1:
    s_mov_b32 s36, 0
K2_rl1:
    buffer_load_dwordx4 v[24:27], v8, s[8:11], s52 offen sc1
    buffer_load_dwordx4 v[56:59], v10, s[8:11], s51 offen offset:1024 sc1
    buffer_load_dwordx4 v[60:63], v10, s[8:11], s51 offen offset:1568 sc1
    s_add_u32 s36, s36, 1
    s_waitcnt vmcnt(0)
    v_max3_u32 v182, v24, v56, v60
    v_cmp_eq_u32 vcc, -1, v182
    s_cbranch_vccz K2_rb1
    s_cmp_lt_u32 s36, 0x40000
    s_cbranch_scc1 K2_rl1
    s_branch K2_rb1
K2_rt2:
    s_mov_b32 s36, 0
K2_rl2:
    buffer_load_dwordx4 v[28:31], v8, s[8:11], s53 offen sc1
    buffer_load_dwordx4 v[64:67], v10, s[8:11], s52 offen offset:1024 sc1
    buffer_load_dwordx4 v[68:71], v10, s[8:11], s52 offen offset:1568 sc1
    s_add_u32 s36, s36, 1
    s_waitcnt vmcnt(0)
    v_max3_u32 v182, v28, v64, v68
    v_cmp_eq_u32 vcc, -1, v182
    s_cbranch_vccz K2_rb2
    s_cmp_lt_u32 s36, 0x40000
    s_cbranch_scc1 K2_rl2
    s_branch K2_rb2
K2_rt3:
    s_mov_b32 s36, 0
K2_rl3:
    buffer_load_dwordx4 v[32:35], v8, s[8:11], s54 offen sc1
    buffer_load_dwordx4 v[72:75], v10, s[8:11], s53 offen offset:1024 sc1
    buffer_load_dwordx4 v[76:79], v10, s[8:11], s53 offen offset:1568 sc1
    s_add_u32 s36, s36, 1
    s_waitcnt vmcnt(0)
    v_max3_u32 v182, v32, v72, v76
    v_cmp_eq_u32 vcc, -1, v182
    s_cbranch_vccz K2_rb3
    s_cmp_lt_u32 s36, 0x40000
    s_cbranch_scc1 K2_rl3
    s_branch K2_rb3
K2_rt4:
    s_mov_b32 s36, 0
K2_rl4:
    buffer_load_dwordx4 v[36:39], v8, s[8:11], s55 offen sc1
    buffer_load_dwordx4 v[80:83], v10, s[8:11], s54 offen offset:1024 sc1
    buffer_load_dwordx4 v[84:87], v10, s[8:11], s54 offen offset:1568 sc1
    s_add_u32 s36, s36, 1
    s_waitcnt vmcnt(0)
    v_max3_u32 v182, v36, v80, v84
    v_cmp_eq_u32 vcc, -1, v182
    s_cbranch_vccz K2_rb4
    s_cmp_lt_u32 s36, 0x40000
    s_cbranch_scc1 K2_rl4
    s_branch K2_rb4
K2_rt5:
    s_mov_b32 s36, 0
K2_rl5:
    buffer_load_dwordx4 v[40:43], v8, s[8:11], s56 offen sc1
    buffer_load_dwordx4 v[88:91], v10, s[8:11], s55 offen offset:1024 sc1
    buffer_load_dwordx4 v[92:95], v10, s[8:11], s55 offen offset:1568 sc1
    s_add_u32 s36, s36, 1
    s_waitcnt vmcnt(0)
    v_max3_u32 v182, v40, v88, v92
    v_cmp_eq_u32 vcc, -1, v182
    s_cbranch_vccz K2_rb5
    s_cmp_lt_u32 s36, 0x40000
    s_cbranch_scc1 K2_rl5
    s_branch K2_rb5
K2_rt6:
    s_mov_b32 s36, 0
K2_rl6:
    buffer_load_dwordx4 v[44:47], v8, s[8:11], s57 offen sc1
    buffer_load_dwordx4 v[96:99], v10, s[8:11], s56 offen offset:1024 sc1
    buffer_load_dwordx4 v[100:103], v10, s[8:11], s56 offen offset:1568 sc1
    s_add_u32 s36, s36, 1
    s_waitcnt vmcnt(0)
    v_max3_u32 v182, v44, v96, v100
    v_cmp_eq_u32 vcc, -1, v182
    s_cbranch_vccz K2_rb6
    s_cmp_lt_u32 s36, 0x40000
    s_cbranch_scc1 K2_rl6
    s_branch K2_rb6
K2_rt7:
    s_mov_b32 s36, 0
K2_rl7:
    buffer_load_dwordx4 v[104:107], v10, s[8:11], s57 offen offset:1024 sc1
    buffer_load_dwordx4 v[108:111], v10, s[8:11], s57 offen offset:1568 sc1
    s_add_u32 s36, s36, 1
    s_waitcnt vmcnt(0)
    v_max_u32 v182, v104, v108
    v_cmp_eq_u32 vcc, -1, v182
    s_cbranch_vccz K2_rb7
    s_cmp_lt_u32 s36, 0x40000
    s_cbranch_scc1 K2_rl7
    s_branch K2_rb7
K2_qspin:
    s_mov_b32 s36, 0
K2_qspin1:
    s_sleep 2
    buffer_load_dword v11, v176, s[8:11], s45 offen sc1
    s_add_u32 s36, s36, 1
    s_waitcnt vmcnt(0)
    v_cmp_ne_u32 vcc, s58, v11
    s_cbranch_vccz K2_qback
    s_cmp_lt_u32 s36, 0x40000
    s_cbranch_scc1 K2_qspin1
    s_branch K2_qback
K2_spin0:
    s_sleep 1
    ds_read_b32 v14, v13 offset:0
    s_waitcnt lgkmcnt(0)
    v_cmp_gt_u32 vcc, s59, v14
    s_cbranch_vccnz K2_spin0
    s_branch K2_back0
K2_spin1:
    s_sleep 1
    ds_read_b32 v14, v13 offset:32
    s_waitcnt lgkmcnt(0)
    v_cmp_gt_u32 vcc, s59, v14
    s_cbranch_vccnz K2_spin1
    s_branch K2_back1

K_all_end:
.section .rodata,"a"
.p2align 6
.amdhsa_kernel sequential_preLN__grouped_kv_mqa__moe_arch_mod__prompt_kernel
  .amdhsa_next_free_vgpr 256
  .amdhsa_next_free_sgpr 102
  .amdhsa_accum_offset 256
  .amdhsa_group_segment_fixed_size 0
  .amdhsa_kernarg_size 104
  .amdhsa_user_sgpr_count 2
  .amdhsa_user_sgpr_kernarg_segment_ptr 1
  .amdhsa_system_sgpr_workgroup_id_x 1
  .amdhsa_float_denorm_mode_32 3
.end_amdhsa_kernel
```
